```python
import torch

def _softmax(x, axis=-1):
    return torch.softmax(x, dim=axis)
def _gelu(x):
    return torch.nn.functional.gelu(x, approximate="tanh")
def _silu(x):
    return torch.nn.functional.silu(x)
def _sigmoid(x):
    return torch.sigmoid(x)
def _layernorm(x, axis=-1, eps=1e-5):
    m = x.mean(dim=axis, keepdim=True)
    v = x.var(dim=axis, keepdim=True, unbiased=False)
    return (x - m) / torch.sqrt(v + eps)
def _scatter_add(tgt, idx, src, axis=0):
    return tgt.clone().index_add_(axis, idx, src)
def _segment_sum(src, seg, n):
    out = torch.zeros((n,) + src.shape[1:], dtype=src.dtype)
    return out.index_add_(0, seg, src)
def _pad(x, pw):
    flat = tuple(v for pair in reversed(pw) for v in pair)
    return torch.nn.functional.pad(x, flat)

kernel_name = 'standalone__weight_only_int_omniquant__prompt'

def setup_inputs():

    _w = (lambda a: (lambda t: t.to(torch.bfloat16) if t.is_floating_point() else t)(torch.as_tensor(a)))
    B, S, D, F = 1, 2048, 1024, 3584
    bits = 3
    G = 64 if 64 > 0 else D
    D = (D // G) * G
    ng = D // G
    qmax = (1 << bits) - 1
    qw = torch.randint(0, qmax + 1, (D, F)).to(torch.int32)
    scales = (torch.abs((lambda *s: torch.randn(*s, dtype=torch.bfloat16) * 0.05)(ng, F)) * 0.05 + 0.01).to(float)
    zeros = torch.randint(0, qmax + 1, (ng, F)).to(float)
    act_scale = (torch.abs((lambda *s: torch.randn(*s, dtype=torch.bfloat16) * 0.05)(D)) * 0.5 + 0.5).to(float)
    return {
        "x": _w((lambda *s: torch.randn(*s, dtype=torch.bfloat16) * 0.05)(B, S, D)),
        "qw": _w(qw),
        "scales": _w(scales),
        "zeros": _w(zeros),
        "act_scale": _w(act_scale),
    }

def reference(x, qw, scales, zeros, act_scale):
    B, S, D = x.shape
    ng, F = scales.shape
    G = D // ng
    s = (lambda x, n, axis: torch.repeat_interleave(x, n, dim=axis))(scales, G, axis=0)
    z = (lambda x, n, axis: torch.repeat_interleave(x, n, dim=axis))(zeros, G, axis=0)
    w = ((lambda x, dt: x.to(dt))(qw, x.dtype) - z) * s
    xs = x * (lambda x, dt: x.to(dt))(act_scale, x.dtype)
    return torch.einsum("bsd,df->bsf", xs, w)
```

```asm
; @launch grid=(256,1,1) block=(512,1,1) lds=152064
.amdgcn_target "amdgcn-amd-amdhsa--gfx950"
.text
.globl standalone__weight_only_int_omniquant__prompt_kernel
.p2align 8
.type standalone__weight_only_int_omniquant__prompt_kernel,@function
standalone__weight_only_int_omniquant__prompt_kernel:
    s_cmp_ge_u32 s2, 256
    s_cbranch_scc1 L_end
    s_cmp_ge_u32 s2, 224
    s_cbranch_scc1 L_prefetch
    s_load_dwordx8 s[4:11], s[0:1], 0
    s_load_dwordx4 s[12:15], s[0:1], 32
    v_lshrrev_b32 v1, 6, v0
    s_and_b32 s16, s2, 7
    s_lshr_b32 s17, s2, 3
    v_readfirstlane_b32 s18, v1
    s_and_b32 s19, s16, 1
    s_lshl_b32 s19, s19, 2
    s_and_b32 s20, s17, 3
    s_lshr_b32 s21, s17, 2
    s_mul_i32 s93, s20, 2
    s_add_u32 s19, s19, s20
    s_lshr_b32 s20, s16, 1
    s_mul_i32 s20, s20, 7
    s_add_u32 s20, s20, s21
    s_mul_i32 s21, s21, 0
    s_add_u32 s93, s93, s21
    s_and_b32 s21, s16, 1
    s_mul_i32 s21, s21, 1
    s_add_u32 s93, s93, s21
    s_and_b32 s93, s93, 7
    v_and_b32 v7, 63, v0
    s_cmp_ge_u32 s18, 4
    s_cbranch_scc1 L_producer
    s_setprio 3
    v_lshrrev_b32 v12, 4, v0
    v_and_b32 v13, 15, v0
    v_mul_u32_u24 v14, 7168, v12
    v_lshl_add_u32 v14, v13, 4, v14
    v_lshlrev_b32 v15, 3, v0
    s_lshl_b32 s23, s20, 8
    s_sub_u32 s34, 114688, s23
    s_mov_b32 s35, 0x20000
    s_mov_b32 s38, s34
    s_mov_b32 s39, 0x20000
    s_mov_b32 s42, 2048
    s_mov_b32 s43, 0x20000
    s_waitcnt lgkmcnt(0)
    s_add_u32 s32, s8, s23
    s_addc_u32 s33, s9, 0
    s_and_b32 s33, s33, 0xffff
    s_add_u32 s36, s10, s23
    s_addc_u32 s37, s11, 0
    s_and_b32 s37, s37, 0xffff
    s_mov_b32 s40, s12
    s_and_b32 s41, s13, 0xffff
    buffer_load_dwordx4 v[16:19], v14, s[32:35], 0 offen
    buffer_load_dwordx4 v[20:23], v14, s[36:39], 0 offen
    buffer_load_dwordx2 v[24:25], v15, s[40:43], 0 offen
    v_lshrrev_b32 v8, 3, v7
    s_lshl_b32 s23, s18, 6
    v_add_u32 v8, s23, v8
    v_lshrrev_b32 v9, 5, v7
    v_lshrrev_b32 v10, 4, v7
    v_xor_b32 v10, v9, v10
    v_and_b32 v10, 1, v10
    v_lshlrev_b32 v10, 2, v10
    v_and_b32 v11, 7, v7
    v_xor_b32 v10, v10, v11
    v_lshlrev_b32 v10, 4, v10
    v_lshl_add_u32 v112, v8, 11, v10
    v_xor_b32 v113, 16, v112
    v_xor_b32 v114, 32, v112
    v_xor_b32 v115, 48, v112
    s_mov_b32 s48, 15360
    s_mov_b32 s49, 30720
    s_mov_b32 s50, 46080
    s_mov_b32 s51, 65536
    s_mov_b32 s52, 80896
    s_mov_b32 s53, 96256
    s_mov_b32 s54, 111616
    s_lshl_b32 s55, s18, 13
    s_lshl_b32 s23, s19, 19
    s_add_u32 s4, s4, s23
    s_addc_u32 s5, s5, 0
    s_and_b32 s5, s5, 0xffff
    s_mov_b32 s10, 522368
    s_mov_b32 s11, 0x20000
    s_mov_b32 s6, 0
    s_mov_b32 s7, 0
    s_add_u32 m0, s55, s7
    s_add_u32 s12, s93, s6
    s_and_b32 s12, s12, 7
    s_and_b32 s13, s6, 8
    s_or_b32 s12, s12, s13
    s_lshl_b32 s12, s12, 7
    s_add_u32 s8, s4, s12
    s_addc_u32 s9, s5, 0
    s_add_u32 s6, s6, 1
    buffer_load_dwordx4 v112, s[8:11], 0 offen offset:0 lds
    buffer_load_dwordx4 v113, s[8:11], s48 offen offset:1024 lds
    buffer_load_dwordx4 v114, s[8:11], s49 offen offset:2048 lds
    buffer_load_dwordx4 v115, s[8:11], s50 offen offset:3072 lds
    s_add_u32 m0, m0, 0x1000
    s_add_u32 s7, s7, 0x8000
    s_cmp_eq_u32 s7, 98304
    s_cselect_b32 s7, 0, s7
    buffer_load_dwordx4 v112, s[8:11], s51 offen offset:0 lds
    buffer_load_dwordx4 v113, s[8:11], s52 offen offset:1024 lds
    buffer_load_dwordx4 v114, s[8:11], s53 offen offset:2048 lds
    buffer_load_dwordx4 v115, s[8:11], s54 offen offset:3072 lds
    s_and_b32 s21, s18, 1
    s_lshr_b32 s22, s18, 1
    v_and_b32 v10, 31, v7
    v_lshrrev_b32 v11, 5, v7
    v_lshrrev_b32 v2, 3, v10
    v_lshrrev_b32 v3, 2, v10
    v_lshrrev_b32 v4, 1, v10
    v_xor_b32 v3, v3, v4
    v_and_b32 v3, 1, v3
    v_lshl_or_b32 v2, v3, 2, v2
    v_xor_b32 v2, v2, v11
    v_lshlrev_b32 v2, 4, v2
    v_lshl_add_u32 v9, v10, 7, v2
    s_lshl_b32 s23, s21, 14
    s_lshl_b32 s24, s22, 13
    s_add_u32 s24, s24, 98304
    v_xor_b32 v8, 0, v9
    v_add_u32 v2, s23, v8
    v_add_u32 v64, s24, v8
    v_xor_b32 v8, 32, v9
    v_add_u32 v3, s23, v8
    v_add_u32 v65, s24, v8
    v_xor_b32 v8, 64, v9
    v_add_u32 v4, s23, v8
    v_add_u32 v66, s24, v8
    v_xor_b32 v8, 96, v9
    v_add_u32 v5, s23, v8
    v_add_u32 v67, s24, v8
    v_mov_b32 v128, 0
    v_mov_b32 v129, 0
    v_mov_b32 v130, 0
    v_mov_b32 v131, 0
    v_mov_b32 v132, 0
    v_mov_b32 v133, 0
    v_mov_b32 v134, 0
    v_mov_b32 v135, 0
    v_mov_b32 v136, 0
    v_mov_b32 v137, 0
    v_mov_b32 v138, 0
    v_mov_b32 v139, 0
    v_mov_b32 v140, 0
    v_mov_b32 v141, 0
    v_mov_b32 v142, 0
    v_mov_b32 v143, 0
    v_mov_b32 v144, 0
    v_mov_b32 v145, 0
    v_mov_b32 v146, 0
    v_mov_b32 v147, 0
    v_mov_b32 v148, 0
    v_mov_b32 v149, 0
    v_mov_b32 v150, 0
    v_mov_b32 v151, 0
    v_mov_b32 v152, 0
    v_mov_b32 v153, 0
    v_mov_b32 v154, 0
    v_mov_b32 v155, 0
    v_mov_b32 v156, 0
    v_mov_b32 v157, 0
    v_mov_b32 v158, 0
    v_mov_b32 v159, 0
    v_mov_b32 v160, 0
    v_mov_b32 v161, 0
    v_mov_b32 v162, 0
    v_mov_b32 v163, 0
    v_mov_b32 v164, 0
    v_mov_b32 v165, 0
    v_mov_b32 v166, 0
    v_mov_b32 v167, 0
    v_mov_b32 v168, 0
    v_mov_b32 v169, 0
    v_mov_b32 v170, 0
    v_mov_b32 v171, 0
    v_mov_b32 v172, 0
    v_mov_b32 v173, 0
    v_mov_b32 v174, 0
    v_mov_b32 v175, 0
    v_mov_b32 v176, 0
    v_mov_b32 v177, 0
    v_mov_b32 v178, 0
    v_mov_b32 v179, 0
    v_mov_b32 v180, 0
    v_mov_b32 v181, 0
    v_mov_b32 v182, 0
    v_mov_b32 v183, 0
    v_mov_b32 v184, 0
    v_mov_b32 v185, 0
    v_mov_b32 v186, 0
    v_mov_b32 v187, 0
    v_mov_b32 v188, 0
    v_mov_b32 v189, 0
    v_mov_b32 v190, 0
    v_mov_b32 v191, 0
    v_mov_b32 v192, 0
    v_mov_b32 v193, 0
    v_mov_b32 v194, 0
    v_mov_b32 v195, 0
    v_mov_b32 v196, 0
    v_mov_b32 v197, 0
    v_mov_b32 v198, 0
    v_mov_b32 v199, 0
    v_mov_b32 v200, 0
    v_mov_b32 v201, 0
    v_mov_b32 v202, 0
    v_mov_b32 v203, 0
    v_mov_b32 v204, 0
    v_mov_b32 v205, 0
    v_mov_b32 v206, 0
    v_mov_b32 v207, 0
    v_mov_b32 v208, 0
    v_mov_b32 v209, 0
    v_mov_b32 v210, 0
    v_mov_b32 v211, 0
    v_mov_b32 v212, 0
    v_mov_b32 v213, 0
    v_mov_b32 v214, 0
    v_mov_b32 v215, 0
    v_mov_b32 v216, 0
    v_mov_b32 v217, 0
    v_mov_b32 v218, 0
    v_mov_b32 v219, 0
    v_mov_b32 v220, 0
    v_mov_b32 v221, 0
    v_mov_b32 v222, 0
    v_mov_b32 v223, 0
    v_mov_b32 v224, 0
    v_mov_b32 v225, 0
    v_mov_b32 v226, 0
    v_mov_b32 v227, 0
    v_mov_b32 v228, 0
    v_mov_b32 v229, 0
    v_mov_b32 v230, 0
    v_mov_b32 v231, 0
    v_mov_b32 v232, 0
    v_mov_b32 v233, 0
    v_mov_b32 v234, 0
    v_mov_b32 v235, 0
    v_mov_b32 v236, 0
    v_mov_b32 v237, 0
    v_mov_b32 v238, 0
    v_mov_b32 v239, 0
    v_mov_b32 v240, 0
    v_mov_b32 v241, 0
    v_mov_b32 v242, 0
    v_mov_b32 v243, 0
    v_mov_b32 v244, 0
    v_mov_b32 v245, 0
    v_mov_b32 v246, 0
    v_mov_b32 v247, 0
    v_mov_b32 v248, 0
    v_mov_b32 v249, 0
    v_mov_b32 v250, 0
    v_mov_b32 v251, 0
    v_mov_b32 v252, 0
    v_mov_b32 v253, 0
    v_mov_b32 v254, 0
    v_mov_b32 v255, 0
    s_mov_b32 s31, 0xffff0000
    s_mov_b32 s30, 0x4b800000
    v_subrev_u32 v74, s93, v12
    v_and_b32 v74, 7, v74
    v_and_b32 v75, 8, v12
    v_or_b32 v74, v74, v75
    v_lshlrev_b32 v72, 9, v74
    v_lshl_add_u32 v72, v13, 5, v72
    v_add_u32 v72, 131072, v72
    v_lshlrev_b32 v73, 8, v74
    v_lshl_add_u32 v73, v13, 4, v73
    v_add_u32 v73, 147456, v73
    s_waitcnt vmcnt(8)
    v_lshlrev_b32 v80, 16, v16
    v_and_b32 v81, s31, v16
    v_lshlrev_b32 v88, 16, v20
    v_and_b32 v89, s31, v20
    v_lshlrev_b32 v82, 16, v17
    v_and_b32 v83, s31, v17
    v_lshlrev_b32 v90, 16, v21
    v_and_b32 v91, s31, v21
    v_lshlrev_b32 v84, 16, v18
    v_and_b32 v85, s31, v18
    v_lshlrev_b32 v92, 16, v22
    v_and_b32 v93, s31, v22
    v_lshlrev_b32 v86, 16, v19
    v_and_b32 v87, s31, v19
    v_lshlrev_b32 v94, 16, v23
    v_and_b32 v95, s31, v23
    v_mul_f32_e64 v88, -v88, v80
    v_mul_f32_e64 v89, -v89, v81
    v_mul_f32_e64 v90, -v90, v82
    v_mul_f32_e64 v91, -v91, v83
    v_mul_f32_e64 v92, -v92, v84
    v_mul_f32_e64 v93, -v93, v85
    v_mul_f32_e64 v94, -v94, v86
    v_mul_f32_e64 v95, -v95, v87
    v_lshlrev_b32 v96, 16, v24
    v_and_b32 v97, s31, v24
    v_lshlrev_b32 v98, 16, v25
    v_and_b32 v99, s31, v25
    ds_write_b128 v72, v[80:83]
    ds_write_b128 v72, v[84:87] offset:16
    ds_write_b128 v72, v[88:91] offset:8192
    ds_write_b128 v72, v[92:95] offset:8208
    ds_write_b128 v73, v[96:99]
    s_lshl_b32 s25, s19, 8
    s_lshl_b32 s26, s21, 7
    s_add_u32 s25, s25, s26
    s_mul_i32 s25, s25, 7168
    s_lshl_b32 s26, s20, 8
    s_lshl_b32 s27, s22, 7
    s_add_u32 s26, s26, s27
    s_add_u32 s25, s25, s26
    s_add_u32 s40, s14, s25
    s_addc_u32 s41, s15, 0
    s_and_b32 s41, s41, 0xffff
    s_sub_u32 s42, 14680064, s25
    s_mov_b32 s43, 0x20000
    v_and_b32 v12, 7, v10
    v_lshlrev_b32 v13, 1, v11
    v_xor_b32 v12, v12, v13
    v_lshlrev_b32 v12, 4, v12
    v_lshl_add_u32 v12, v10, 7, v12
    s_lshl_b32 s26, s18, 14
    s_add_u32 s26, s26, 32768
    v_add_u32 v12, s26, v12
    s_waitcnt lgkmcnt(0)
    v_xor_b32 v72, 0, v12
    v_xor_b32 v73, 16, v12
    v_xor_b32 v74, 64, v12
    v_xor_b32 v75, 80, v12
    v_lshrrev_b32 v13, 3, v7
    v_and_b32 v14, 7, v7
    v_xor_b32 v15, v14, v13
    v_lshlrev_b32 v15, 4, v15
    v_lshl_add_u32 v15, v13, 7, v15
    v_add_u32 v76, s26, v15
    v_mul_u32_u24 v77, 7168, v13
    v_lshl_add_u32 v77, v14, 4, v77
    s_mov_b32 s28, 0
    s_mov_b32 s29, 0
    s_mov_b32 s44, 0x8000
    s_mov_b32 s45, 0xffff0000
    s_barrier
    s_add_u32 m0, s55, s7
    s_add_u32 s12, s93, s6
    s_and_b32 s12, s12, 7
    s_and_b32 s13, s6, 8
    s_or_b32 s12, s12, s13
    s_lshl_b32 s12, s12, 7
    s_add_u32 s8, s4, s12
    s_addc_u32 s9, s5, 0
    s_add_u32 s6, s6, 1
    buffer_load_dwordx4 v112, s[8:11], 0 offen offset:0 lds
    buffer_load_dwordx4 v113, s[8:11], s48 offen offset:1024 lds
    buffer_load_dwordx4 v114, s[8:11], s49 offen offset:2048 lds
    buffer_load_dwordx4 v115, s[8:11], s50 offen offset:3072 lds
    s_add_u32 m0, m0, 0x1000
    s_add_u32 s7, s7, 0x8000
    s_cmp_eq_u32 s7, 98304
    s_cselect_b32 s7, 0, s7
    buffer_load_dwordx4 v112, s[8:11], s51 offen offset:0 lds
    buffer_load_dwordx4 v113, s[8:11], s52 offen offset:1024 lds
    buffer_load_dwordx4 v114, s[8:11], s53 offen offset:2048 lds
    buffer_load_dwordx4 v115, s[8:11], s54 offen offset:3072 lds
    s_waitcnt vmcnt(8)
    s_barrier
    ds_read_b128 v[32:35], v64 offset:0
    ds_read_b128 v[16:19], v2 offset:0
    ds_read_b128 v[20:23], v2 offset:4096
    ds_read_b128 v[24:27], v2 offset:8192
    ds_read_b128 v[28:31], v2 offset:12288
    ds_read_b128 v[36:39], v64 offset:4096
    s_add_u32 m0, s55, s7
    s_add_u32 s12, s93, s6
    s_and_b32 s12, s12, 7
    s_and_b32 s13, s6, 8
    s_or_b32 s12, s12, s13
    s_lshl_b32 s12, s12, 7
    s_add_u32 s8, s4, s12
    s_addc_u32 s9, s5, 0
    s_add_u32 s6, s6, 1
    buffer_load_dwordx4 v112, s[8:11], 0 offen offset:0 lds
    buffer_load_dwordx4 v113, s[8:11], s48 offen offset:1024 lds
    s_branch L_cB0
.p2align 6
L_cloop:
    s_waitcnt vmcnt(8)
    s_waitcnt lgkmcnt(0)
    s_barrier
    ds_read_b128 v[32:35], v64 offset:0
    v_mfma_f32_32x32x16_bf16 v[128:143], v[56:59], v[40:43], v[128:143]
    ds_read_b128 v[16:19], v2 offset:0
    v_mfma_f32_32x32x16_bf16 v[144:159], v[56:59], v[44:47], v[144:159]
    s_add_u32 m0, s55, s7
    s_add_u32 s12, s93, s6
    s_and_b32 s12, s12, 7
    s_and_b32 s13, s6, 8
    s_or_b32 s12, s12, s13
    s_lshl_b32 s12, s12, 7
    s_add_u32 s8, s4, s12
    s_addc_u32 s9, s5, 0
    s_add_u32 s6, s6, 1
    buffer_load_dwordx4 v112, s[8:11], 0 offen offset:0 lds
    ds_read_b128 v[20:23], v2 offset:4096
    v_mfma_f32_32x32x16_bf16 v[160:175], v[56:59], v[48:51], v[160:175]
    ds_read_b128 v[24:27], v2 offset:8192
    v_mfma_f32_32x32x16_bf16 v[176:191], v[56:59], v[52:55], v[176:191]
    ds_read_b128 v[28:31], v2 offset:12288
    v_mfma_f32_32x32x16_bf16 v[192:207], v[60:63], v[40:43], v[192:207]
    ds_read_b128 v[36:39], v64 offset:4096
    v_mfma_f32_32x32x16_bf16 v[208:223], v[60:63], v[44:47], v[208:223]
    buffer_load_dwordx4 v113, s[8:11], s48 offen offset:1024 lds
    v_mfma_f32_32x32x16_bf16 v[224:239], v[60:63], v[48:51], v[224:239]
    v_mfma_f32_32x32x16_bf16 v[240:255], v[60:63], v[52:55], v[240:255]
L_cB0:
    ds_read_b128 v[56:59], v65 offset:0
    s_waitcnt lgkmcnt(5)
    v_mfma_f32_32x32x16_bf16 v[128:143], v[32:35], v[16:19], v[128:143]
    ds_read_b128 v[40:43], v3 offset:0
    s_waitcnt lgkmcnt(5)
    v_mfma_f32_32x32x16_bf16 v[144:159], v[32:35], v[20:23], v[144:159]
    buffer_load_dwordx4 v114, s[8:11], s49 offen offset:2048 lds
    ds_read_b128 v[44:47], v3 offset:4096
    s_waitcnt lgkmcnt(5)
    v_mfma_f32_32x32x16_bf16 v[160:175], v[32:35], v[24:27], v[160:175]
    ds_read_b128 v[48:51], v3 offset:8192
    s_waitcnt lgkmcnt(5)
    v_mfma_f32_32x32x16_bf16 v[176:191], v[32:35], v[28:31], v[176:191]
    ds_read_b128 v[52:55], v3 offset:12288
    s_waitcnt lgkmcnt(5)
    v_mfma_f32_32x32x16_bf16 v[192:207], v[36:39], v[16:19], v[192:207]
    ds_read_b128 v[60:63], v65 offset:4096
    v_mfma_f32_32x32x16_bf16 v[208:223], v[36:39], v[20:23], v[208:223]
    buffer_load_dwordx4 v115, s[8:11], s50 offen offset:3072 lds
    v_mfma_f32_32x32x16_bf16 v[224:239], v[36:39], v[24:27], v[224:239]
    v_mfma_f32_32x32x16_bf16 v[240:255], v[36:39], v[28:31], v[240:255]
    ds_read_b128 v[32:35], v66 offset:0
    s_waitcnt lgkmcnt(5)
    v_mfma_f32_32x32x16_bf16 v[128:143], v[56:59], v[40:43], v[128:143]
    ds_read_b128 v[16:19], v4 offset:0
    s_waitcnt lgkmcnt(5)
    v_mfma_f32_32x32x16_bf16 v[144:159], v[56:59], v[44:47], v[144:159]
    s_add_u32 m0, m0, 0x1000
    s_add_u32 s7, s7, 0x8000
    s_cmp_eq_u32 s7, 98304
    s_cselect_b32 s7, 0, s7
    buffer_load_dwordx4 v112, s[8:11], s51 offen offset:0 lds
    ds_read_b128 v[20:23], v4 offset:4096
    s_waitcnt lgkmcnt(5)
    v_mfma_f32_32x32x16_bf16 v[160:175], v[56:59], v[48:51], v[160:175]
    ds_read_b128 v[24:27], v4 offset:8192
    s_waitcnt lgkmcnt(5)
    v_mfma_f32_32x32x16_bf16 v[176:191], v[56:59], v[52:55], v[176:191]
    ds_read_b128 v[28:31], v4 offset:12288
    s_waitcnt lgkmcnt(5)
    v_mfma_f32_32x32x16_bf16 v[192:207], v[60:63], v[40:43], v[192:207]
    ds_read_b128 v[36:39], v66 offset:4096
    v_mfma_f32_32x32x16_bf16 v[208:223], v[60:63], v[44:47], v[208:223]
    buffer_load_dwordx4 v113, s[8:11], s52 offen offset:1024 lds
    v_mfma_f32_32x32x16_bf16 v[224:239], v[60:63], v[48:51], v[224:239]
    v_mfma_f32_32x32x16_bf16 v[240:255], v[60:63], v[52:55], v[240:255]
    ds_read_b128 v[56:59], v67 offset:0
    s_waitcnt lgkmcnt(5)
    v_mfma_f32_32x32x16_bf16 v[128:143], v[32:35], v[16:19], v[128:143]
    ds_read_b128 v[40:43], v5 offset:0
    s_waitcnt lgkmcnt(5)
    v_mfma_f32_32x32x16_bf16 v[144:159], v[32:35], v[20:23], v[144:159]
    buffer_load_dwordx4 v114, s[8:11], s53 offen offset:2048 lds
    ds_read_b128 v[44:47], v5 offset:4096
    s_waitcnt lgkmcnt(5)
    v_mfma_f32_32x32x16_bf16 v[160:175], v[32:35], v[24:27], v[160:175]
    ds_read_b128 v[48:51], v5 offset:8192
    s_waitcnt lgkmcnt(5)
    v_mfma_f32_32x32x16_bf16 v[176:191], v[32:35], v[28:31], v[176:191]
    ds_read_b128 v[52:55], v5 offset:12288
    s_waitcnt lgkmcnt(5)
    v_mfma_f32_32x32x16_bf16 v[192:207], v[36:39], v[16:19], v[192:207]
    ds_read_b128 v[60:63], v67 offset:4096
    v_mfma_f32_32x32x16_bf16 v[208:223], v[36:39], v[20:23], v[208:223]
    buffer_load_dwordx4 v115, s[8:11], s54 offen offset:3072 lds
    v_mfma_f32_32x32x16_bf16 v[224:239], v[36:39], v[24:27], v[224:239]
    s_cmp_eq_u32 s29, 2
    s_cselect_b32 s46, s45, s44
    s_cselect_b32 s47, -1, s29
    s_add_u32 s29, s47, 1
    v_add_u32 v2, s46, v2
    v_add_u32 v3, s46, v3
    v_add_u32 v4, s46, v4
    v_add_u32 v5, s46, v5
    v_mfma_f32_32x32x16_bf16 v[240:255], v[36:39], v[28:31], v[240:255]
    s_waitcnt vmcnt(8)
    s_waitcnt lgkmcnt(0)
    s_barrier
    ds_read_b128 v[32:35], v64 offset:16384
    v_mfma_f32_32x32x16_bf16 v[128:143], v[56:59], v[40:43], v[128:143]
    ds_read_b128 v[16:19], v2 offset:0
    v_mfma_f32_32x32x16_bf16 v[144:159], v[56:59], v[44:47], v[144:159]
    s_add_u32 m0, s55, s7
    s_add_u32 s12, s93, s6
    s_and_b32 s12, s12, 7
    s_and_b32 s13, s6, 8
    s_or_b32 s12, s12, s13
    s_lshl_b32 s12, s12, 7
    s_add_u32 s8, s4, s12
    s_addc_u32 s9, s5, 0
    s_add_u32 s6, s6, 1
    buffer_load_dwordx4 v112, s[8:11], 0 offen offset:0 lds
    ds_read_b128 v[20:23], v2 offset:4096
    v_mfma_f32_32x32x16_bf16 v[160:175], v[56:59], v[48:51], v[160:175]
    ds_read_b128 v[24:27], v2 offset:8192
    v_mfma_f32_32x32x16_bf16 v[176:191], v[56:59], v[52:55], v[176:191]
    ds_read_b128 v[28:31], v2 offset:12288
    v_mfma_f32_32x32x16_bf16 v[192:207], v[60:63], v[40:43], v[192:207]
    ds_read_b128 v[36:39], v64 offset:20480
    v_mfma_f32_32x32x16_bf16 v[208:223], v[60:63], v[44:47], v[208:223]
    buffer_load_dwordx4 v113, s[8:11], s48 offen offset:1024 lds
    v_mfma_f32_32x32x16_bf16 v[224:239], v[60:63], v[48:51], v[224:239]
    v_mfma_f32_32x32x16_bf16 v[240:255], v[60:63], v[52:55], v[240:255]
    ds_read_b128 v[56:59], v65 offset:16384
    s_waitcnt lgkmcnt(5)
    v_mfma_f32_32x32x16_bf16 v[128:143], v[32:35], v[16:19], v[128:143]
    ds_read_b128 v[40:43], v3 offset:0
    s_waitcnt lgkmcnt(5)
    v_mfma_f32_32x32x16_bf16 v[144:159], v[32:35], v[20:23], v[144:159]
    buffer_load_dwordx4 v114, s[8:11], s49 offen offset:2048 lds
    ds_read_b128 v[44:47], v3 offset:4096
    s_waitcnt lgkmcnt(5)
    v_mfma_f32_32x32x16_bf16 v[160:175], v[32:35], v[24:27], v[160:175]
    ds_read_b128 v[48:51], v3 offset:8192
    s_waitcnt lgkmcnt(5)
    v_mfma_f32_32x32x16_bf16 v[176:191], v[32:35], v[28:31], v[176:191]
    ds_read_b128 v[52:55], v3 offset:12288
    s_waitcnt lgkmcnt(5)
    v_mfma_f32_32x32x16_bf16 v[192:207], v[36:39], v[16:19], v[192:207]
    ds_read_b128 v[60:63], v65 offset:20480
    v_mfma_f32_32x32x16_bf16 v[208:223], v[36:39], v[20:23], v[208:223]
    buffer_load_dwordx4 v115, s[8:11], s50 offen offset:3072 lds
    v_mfma_f32_32x32x16_bf16 v[224:239], v[36:39], v[24:27], v[224:239]
    v_mfma_f32_32x32x16_bf16 v[240:255], v[36:39], v[28:31], v[240:255]
    ds_read_b128 v[32:35], v66 offset:16384
    s_waitcnt lgkmcnt(5)
    v_mfma_f32_32x32x16_bf16 v[128:143], v[56:59], v[40:43], v[128:143]
    ds_read_b128 v[16:19], v4 offset:0
    s_waitcnt lgkmcnt(5)
    v_mfma_f32_32x32x16_bf16 v[144:159], v[56:59], v[44:47], v[144:159]
    s_add_u32 m0, m0, 0x1000
    s_add_u32 s7, s7, 0x8000
    s_cmp_eq_u32 s7, 98304
    s_cselect_b32 s7, 0, s7
    buffer_load_dwordx4 v112, s[8:11], s51 offen offset:0 lds
    ds_read_b128 v[20:23], v4 offset:4096
    s_waitcnt lgkmcnt(5)
    v_mfma_f32_32x32x16_bf16 v[160:175], v[56:59], v[48:51], v[160:175]
    ds_read_b128 v[24:27], v4 offset:8192
    s_waitcnt lgkmcnt(5)
    v_mfma_f32_32x32x16_bf16 v[176:191], v[56:59], v[52:55], v[176:191]
    ds_read_b128 v[28:31], v4 offset:12288
    s_waitcnt lgkmcnt(5)
    v_mfma_f32_32x32x16_bf16 v[192:207], v[60:63], v[40:43], v[192:207]
    ds_read_b128 v[36:39], v66 offset:20480
    v_mfma_f32_32x32x16_bf16 v[208:223], v[60:63], v[44:47], v[208:223]
    buffer_load_dwordx4 v113, s[8:11], s52 offen offset:1024 lds
    v_mfma_f32_32x32x16_bf16 v[224:239], v[60:63], v[48:51], v[224:239]
    v_mfma_f32_32x32x16_bf16 v[240:255], v[60:63], v[52:55], v[240:255]
    ds_read_b128 v[56:59], v67 offset:16384
    s_waitcnt lgkmcnt(5)
    v_mfma_f32_32x32x16_bf16 v[128:143], v[32:35], v[16:19], v[128:143]
    ds_read_b128 v[40:43], v5 offset:0
    s_waitcnt lgkmcnt(5)
    v_mfma_f32_32x32x16_bf16 v[144:159], v[32:35], v[20:23], v[144:159]
    buffer_load_dwordx4 v114, s[8:11], s53 offen offset:2048 lds
    ds_read_b128 v[44:47], v5 offset:4096
    s_waitcnt lgkmcnt(5)
    v_mfma_f32_32x32x16_bf16 v[160:175], v[32:35], v[24:27], v[160:175]
    ds_read_b128 v[48:51], v5 offset:8192
    s_waitcnt lgkmcnt(5)
    v_mfma_f32_32x32x16_bf16 v[176:191], v[32:35], v[28:31], v[176:191]
    ds_read_b128 v[52:55], v5 offset:12288
    s_waitcnt lgkmcnt(5)
    v_mfma_f32_32x32x16_bf16 v[192:207], v[36:39], v[16:19], v[192:207]
    ds_read_b128 v[60:63], v67 offset:20480
    v_mfma_f32_32x32x16_bf16 v[208:223], v[36:39], v[20:23], v[208:223]
    buffer_load_dwordx4 v115, s[8:11], s54 offen offset:3072 lds
    v_mfma_f32_32x32x16_bf16 v[224:239], v[36:39], v[24:27], v[224:239]
    s_cmp_eq_u32 s29, 2
    s_cselect_b32 s46, s45, s44
    s_cselect_b32 s47, -1, s29
    s_add_u32 s29, s47, 1
    v_add_u32 v2, s46, v2
    v_add_u32 v3, s46, v3
    v_add_u32 v4, s46, v4
    v_add_u32 v5, s46, v5
    v_mfma_f32_32x32x16_bf16 v[240:255], v[36:39], v[28:31], v[240:255]
    s_add_u32 s28, s28, 1
    s_cmp_lt_u32 s28, 7
    s_cbranch_scc1 L_cloop
    s_waitcnt vmcnt(8)
    s_waitcnt lgkmcnt(0)
    s_barrier
    ds_read_b128 v[32:35], v64 offset:0
    v_mfma_f32_32x32x16_bf16 v[128:143], v[56:59], v[40:43], v[128:143]
    ds_read_b128 v[16:19], v2 offset:0
    v_mfma_f32_32x32x16_bf16 v[144:159], v[56:59], v[44:47], v[144:159]
    ds_read_b128 v[20:23], v2 offset:4096
    v_mfma_f32_32x32x16_bf16 v[160:175], v[56:59], v[48:51], v[160:175]
    ds_read_b128 v[24:27], v2 offset:8192
    v_mfma_f32_32x32x16_bf16 v[176:191], v[56:59], v[52:55], v[176:191]
    ds_read_b128 v[28:31], v2 offset:12288
    v_mfma_f32_32x32x16_bf16 v[192:207], v[60:63], v[40:43], v[192:207]
    ds_read_b128 v[36:39], v64 offset:4096
    v_mfma_f32_32x32x16_bf16 v[208:223], v[60:63], v[44:47], v[208:223]
    v_mfma_f32_32x32x16_bf16 v[224:239], v[60:63], v[48:51], v[224:239]
    v_mfma_f32_32x32x16_bf16 v[240:255], v[60:63], v[52:55], v[240:255]
    ds_read_b128 v[56:59], v65 offset:0
    s_waitcnt lgkmcnt(5)
    v_mfma_f32_32x32x16_bf16 v[128:143], v[32:35], v[16:19], v[128:143]
    ds_read_b128 v[40:43], v3 offset:0
    s_waitcnt lgkmcnt(5)
    v_mfma_f32_32x32x16_bf16 v[144:159], v[32:35], v[20:23], v[144:159]
    ds_read_b128 v[44:47], v3 offset:4096
    s_waitcnt lgkmcnt(5)
    v_mfma_f32_32x32x16_bf16 v[160:175], v[32:35], v[24:27], v[160:175]
    ds_read_b128 v[48:51], v3 offset:8192
    s_waitcnt lgkmcnt(5)
    v_mfma_f32_32x32x16_bf16 v[176:191], v[32:35], v[28:31], v[176:191]
    ds_read_b128 v[52:55], v3 offset:12288
    s_waitcnt lgkmcnt(5)
    v_mfma_f32_32x32x16_bf16 v[192:207], v[36:39], v[16:19], v[192:207]
    ds_read_b128 v[60:63], v65 offset:4096
    v_mfma_f32_32x32x16_bf16 v[208:223], v[36:39], v[20:23], v[208:223]
    v_mfma_f32_32x32x16_bf16 v[224:239], v[36:39], v[24:27], v[224:239]
    v_mfma_f32_32x32x16_bf16 v[240:255], v[36:39], v[28:31], v[240:255]
    ds_read_b128 v[32:35], v66 offset:0
    s_waitcnt lgkmcnt(5)
    v_mfma_f32_32x32x16_bf16 v[128:143], v[56:59], v[40:43], v[128:143]
    ds_read_b128 v[16:19], v4 offset:0
    s_waitcnt lgkmcnt(5)
    v_mfma_f32_32x32x16_bf16 v[144:159], v[56:59], v[44:47], v[144:159]
    ds_read_b128 v[20:23], v4 offset:4096
    s_waitcnt lgkmcnt(5)
    v_mfma_f32_32x32x16_bf16 v[160:175], v[56:59], v[48:51], v[160:175]
    ds_read_b128 v[24:27], v4 offset:8192
    s_waitcnt lgkmcnt(5)
    v_mfma_f32_32x32x16_bf16 v[176:191], v[56:59], v[52:55], v[176:191]
    ds_read_b128 v[28:31], v4 offset:12288
    s_waitcnt lgkmcnt(5)
    v_mfma_f32_32x32x16_bf16 v[192:207], v[60:63], v[40:43], v[192:207]
    ds_read_b128 v[36:39], v66 offset:4096
    v_mfma_f32_32x32x16_bf16 v[208:223], v[60:63], v[44:47], v[208:223]
    v_mfma_f32_32x32x16_bf16 v[224:239], v[60:63], v[48:51], v[224:239]
    v_mfma_f32_32x32x16_bf16 v[240:255], v[60:63], v[52:55], v[240:255]
    ds_read_b128 v[56:59], v67 offset:0
    s_waitcnt lgkmcnt(5)
    v_mfma_f32_32x32x16_bf16 v[128:143], v[32:35], v[16:19], v[128:143]
    ds_read_b128 v[40:43], v5 offset:0
    s_waitcnt lgkmcnt(5)
    v_mfma_f32_32x32x16_bf16 v[144:159], v[32:35], v[20:23], v[144:159]
    ds_read_b128 v[44:47], v5 offset:4096
    s_waitcnt lgkmcnt(5)
    v_mfma_f32_32x32x16_bf16 v[160:175], v[32:35], v[24:27], v[160:175]
    ds_read_b128 v[48:51], v5 offset:8192
    s_waitcnt lgkmcnt(5)
    v_mfma_f32_32x32x16_bf16 v[176:191], v[32:35], v[28:31], v[176:191]
    ds_read_b128 v[52:55], v5 offset:12288
    s_waitcnt lgkmcnt(5)
    v_mfma_f32_32x32x16_bf16 v[192:207], v[36:39], v[16:19], v[192:207]
    ds_read_b128 v[60:63], v67 offset:4096
    v_mfma_f32_32x32x16_bf16 v[208:223], v[36:39], v[20:23], v[208:223]
    v_mfma_f32_32x32x16_bf16 v[224:239], v[36:39], v[24:27], v[224:239]
    s_cmp_eq_u32 s29, 2
    s_cselect_b32 s46, s45, s44
    s_cselect_b32 s47, -1, s29
    s_add_u32 s29, s47, 1
    v_add_u32 v2, s46, v2
    v_add_u32 v3, s46, v3
    v_add_u32 v4, s46, v4
    v_add_u32 v5, s46, v5
    v_mfma_f32_32x32x16_bf16 v[240:255], v[36:39], v[28:31], v[240:255]
    s_waitcnt vmcnt(0)
    s_waitcnt lgkmcnt(0)
    s_barrier
    s_mov_b32 s27, 0
    v_mfma_f32_32x32x16_bf16 v[128:143], v[56:59], v[40:43], v[128:143]
    ds_read_b128 v[96:99], v64 offset:16384
    ds_read_b128 v[16:19], v2 offset:0
    v_mfma_f32_32x32x16_bf16 v[144:159], v[56:59], v[44:47], v[144:159]
    ds_read_b128 v[100:103], v64 offset:20480
    ds_read_b128 v[104:107], v65 offset:16384
    v_mfma_f32_32x32x16_bf16 v[160:175], v[56:59], v[48:51], v[160:175]
    ds_read_b128 v[20:23], v3 offset:0
    ds_read_b128 v[108:111], v65 offset:20480
    v_mfma_f32_32x32x16_bf16 v[176:191], v[56:59], v[52:55], v[176:191]
    ds_read_b128 v[112:115], v66 offset:16384
    ds_read_b128 v[24:27], v4 offset:0
    v_mfma_f32_32x32x16_bf16 v[192:207], v[60:63], v[40:43], v[192:207]
    ds_read_b128 v[116:119], v66 offset:20480
    v_mfma_f32_32x32x16_bf16 v[208:223], v[60:63], v[44:47], v[208:223]
    ds_read_b128 v[120:123], v67 offset:16384
    v_mfma_f32_32x32x16_bf16 v[224:239], v[60:63], v[48:51], v[224:239]
    ds_read_b128 v[28:31], v5 offset:0
    v_mfma_f32_32x32x16_bf16 v[240:255], v[60:63], v[52:55], v[240:255]
    ds_read_b128 v[124:127], v67 offset:20480
    s_waitcnt lgkmcnt(10)
    v_mfma_f32_32x32x16_bf16 v[128:143], v[96:99], v[16:19], v[128:143]
    ds_read_b128 v[40:43], v2 offset:4096
    ds_read_b128 v[44:47], v3 offset:4096
    s_waitcnt lgkmcnt(11)
    v_mfma_f32_32x32x16_bf16 v[192:207], v[100:103], v[16:19], v[192:207]
    ds_read_b128 v[48:51], v4 offset:4096
    s_waitcnt lgkmcnt(10)
    v_mfma_f32_32x32x16_bf16 v[128:143], v[104:107], v[20:23], v[128:143]
    ds_read_b128 v[52:55], v5 offset:4096
    s_waitcnt lgkmcnt(10)
    v_mfma_f32_32x32x16_bf16 v[192:207], v[108:111], v[20:23], v[192:207]
    s_waitcnt lgkmcnt(8)
    v_mfma_f32_32x32x16_bf16 v[128:143], v[112:115], v[24:27], v[128:143]
    s_waitcnt lgkmcnt(7)
    v_mfma_f32_32x32x16_bf16 v[192:207], v[116:119], v[24:27], v[192:207]
    s_waitcnt lgkmcnt(5)
    v_mfma_f32_32x32x16_bf16 v[128:143], v[120:123], v[28:31], v[128:143]
    s_waitcnt lgkmcnt(4)
    v_mfma_f32_32x32x16_bf16 v[192:207], v[124:127], v[28:31], v[192:207]
    s_waitcnt lgkmcnt(3)
    v_mfma_f32_32x32x16_bf16 v[144:159], v[96:99], v[40:43], v[144:159]
    ds_read_b128 v[16:19], v2 offset:8192
    ds_read_b128 v[20:23], v3 offset:8192
    s_waitcnt lgkmcnt(5)
    v_mfma_f32_32x32x16_bf16 v[208:223], v[100:103], v[40:43], v[208:223]
    ds_read_b128 v[24:27], v4 offset:8192
    s_waitcnt lgkmcnt(5)
    v_mfma_f32_32x32x16_bf16 v[144:159], v[104:107], v[44:47], v[144:159]
    ds_read_b128 v[28:31], v5 offset:8192
    v_cvt_pk_bf16_f32 v80, v128, v129
    v_cvt_pk_bf16_f32 v81, v130, v131
    v_cvt_pk_bf16_f32 v82, v132, v133
    v_cvt_pk_bf16_f32 v83, v134, v135
    s_waitcnt lgkmcnt(6)
    v_mfma_f32_32x32x16_bf16 v[208:223], v[108:111], v[44:47], v[208:223]
    v_cvt_pk_bf16_f32 v84, v136, v137
    v_cvt_pk_bf16_f32 v85, v138, v139
    v_cvt_pk_bf16_f32 v86, v140, v141
    v_cvt_pk_bf16_f32 v87, v142, v143
    s_waitcnt lgkmcnt(5)
    v_mfma_f32_32x32x16_bf16 v[144:159], v[112:115], v[48:51], v[144:159]
    ds_write_b128 v72, v[80:83] offset:0
    ds_write_b128 v73, v[84:87] offset:0
    v_cvt_pk_bf16_f32 v88, v192, v193
    v_cvt_pk_bf16_f32 v89, v194, v195
    s_waitcnt lgkmcnt(7)
    v_mfma_f32_32x32x16_bf16 v[208:223], v[116:119], v[48:51], v[208:223]
    v_cvt_pk_bf16_f32 v90, v196, v197
    v_cvt_pk_bf16_f32 v91, v198, v199
    v_cvt_pk_bf16_f32 v92, v200, v201
    v_cvt_pk_bf16_f32 v93, v202, v203
    s_waitcnt lgkmcnt(6)
    v_mfma_f32_32x32x16_bf16 v[144:159], v[120:123], v[52:55], v[144:159]
    v_cvt_pk_bf16_f32 v94, v204, v205
    v_cvt_pk_bf16_f32 v95, v206, v207
    ds_write_b128 v74, v[88:91] offset:0
    ds_write_b128 v75, v[92:95] offset:0
    s_waitcnt lgkmcnt(8)
    v_mfma_f32_32x32x16_bf16 v[208:223], v[124:127], v[52:55], v[208:223]
    ds_read_b128 v[32:35], v76 offset:0
    ds_read_b128 v[36:39], v76 offset:1024
    ds_read_b128 v[56:59], v76 offset:2048
    ds_read_b128 v[60:63], v76 offset:3072
    s_waitcnt lgkmcnt(11)
    v_mfma_f32_32x32x16_bf16 v[160:175], v[96:99], v[16:19], v[160:175]
    ds_read_b128 v[40:43], v2 offset:12288
    ds_read_b128 v[44:47], v3 offset:12288
    ds_read_b128 v[48:51], v4 offset:12288
    ds_read_b128 v[52:55], v5 offset:12288
    v_mfma_f32_32x32x16_bf16 v[224:239], v[100:103], v[16:19], v[224:239]
    s_waitcnt lgkmcnt(7)
    buffer_store_dwordx4 v[32:35], v77, s[40:43], s27 offen nt
    s_add_u32 s27, s27, 57344
    s_waitcnt lgkmcnt(6)
    buffer_store_dwordx4 v[36:39], v77, s[40:43], s27 offen nt
    s_add_u32 s27, s27, 57344
    s_waitcnt lgkmcnt(14)
    v_mfma_f32_32x32x16_bf16 v[160:175], v[104:107], v[20:23], v[160:175]
    s_waitcnt lgkmcnt(5)
    buffer_store_dwordx4 v[56:59], v77, s[40:43], s27 offen nt
    s_add_u32 s27, s27, 57344
    s_waitcnt lgkmcnt(4)
    buffer_store_dwordx4 v[60:63], v77, s[40:43], s27 offen nt
    s_add_u32 s27, s27, 57344
    v_cvt_pk_bf16_f32 v80, v144, v145
    v_cvt_pk_bf16_f32 v81, v146, v147
    v_cvt_pk_bf16_f32 v82, v148, v149
    v_cvt_pk_bf16_f32 v83, v150, v151
    s_waitcnt lgkmcnt(14)
    v_mfma_f32_32x32x16_bf16 v[224:239], v[108:111], v[20:23], v[224:239]
    v_cvt_pk_bf16_f32 v84, v152, v153
    v_cvt_pk_bf16_f32 v85, v154, v155
    v_cvt_pk_bf16_f32 v86, v156, v157
    v_cvt_pk_bf16_f32 v87, v158, v159
    s_waitcnt lgkmcnt(13)
    v_mfma_f32_32x32x16_bf16 v[160:175], v[112:115], v[24:27], v[160:175]
    ds_write_b128 v72, v[80:83] offset:4096
    ds_write_b128 v73, v[84:87] offset:4096
    v_cvt_pk_bf16_f32 v88, v208, v209
    v_cvt_pk_bf16_f32 v89, v210, v211
    v_mfma_f32_32x32x16_bf16 v[224:239], v[116:119], v[24:27], v[224:239]
    v_cvt_pk_bf16_f32 v90, v212, v213
    v_cvt_pk_bf16_f32 v91, v214, v215
    v_cvt_pk_bf16_f32 v92, v216, v217
    v_cvt_pk_bf16_f32 v93, v218, v219
    s_waitcnt lgkmcnt(14)
    v_mfma_f32_32x32x16_bf16 v[160:175], v[120:123], v[28:31], v[160:175]
    v_cvt_pk_bf16_f32 v94, v220, v221
    v_cvt_pk_bf16_f32 v95, v222, v223
    ds_write_b128 v74, v[88:91] offset:4096
    ds_write_b128 v75, v[92:95] offset:4096
    v_mfma_f32_32x32x16_bf16 v[224:239], v[124:127], v[28:31], v[224:239]
    ds_read_b128 v[32:35], v76 offset:4096
    ds_read_b128 v[36:39], v76 offset:5120
    ds_read_b128 v[56:59], v76 offset:6144
    ds_read_b128 v[60:63], v76 offset:7168
    s_waitcnt lgkmcnt(11)
    v_mfma_f32_32x32x16_bf16 v[176:191], v[96:99], v[40:43], v[176:191]
    s_waitcnt lgkmcnt(3)
    buffer_store_dwordx4 v[32:35], v77, s[40:43], s27 offen nt
    s_add_u32 s27, s27, 57344
    s_waitcnt lgkmcnt(2)
    buffer_store_dwordx4 v[36:39], v77, s[40:43], s27 offen nt
    s_add_u32 s27, s27, 57344
    s_waitcnt lgkmcnt(11)
    v_mfma_f32_32x32x16_bf16 v[240:255], v[100:103], v[40:43], v[240:255]
    s_waitcnt lgkmcnt(1)
    buffer_store_dwordx4 v[56:59], v77, s[40:43], s27 offen nt
    s_add_u32 s27, s27, 57344
    s_waitcnt lgkmcnt(10)
    v_mfma_f32_32x32x16_bf16 v[176:191], v[104:107], v[44:47], v[176:191]
    s_waitcnt lgkmcnt(0)
    buffer_store_dwordx4 v[60:63], v77, s[40:43], s27 offen nt
    s_add_u32 s27, s27, 57344
    v_cvt_pk_bf16_f32 v80, v160, v161
    v_cvt_pk_bf16_f32 v81, v162, v163
    v_cvt_pk_bf16_f32 v82, v164, v165
    v_cvt_pk_bf16_f32 v83, v166, v167
    s_waitcnt lgkmcnt(10)
    v_mfma_f32_32x32x16_bf16 v[240:255], v[108:111], v[44:47], v[240:255]
    v_cvt_pk_bf16_f32 v84, v168, v169
    v_cvt_pk_bf16_f32 v85, v170, v171
    v_cvt_pk_bf16_f32 v86, v172, v173
    v_cvt_pk_bf16_f32 v87, v174, v175
    s_waitcnt lgkmcnt(9)
    v_mfma_f32_32x32x16_bf16 v[176:191], v[112:115], v[48:51], v[176:191]
    ds_write_b128 v72, v[80:83] offset:8192
    ds_write_b128 v73, v[84:87] offset:8192
    v_cvt_pk_bf16_f32 v88, v224, v225
    v_cvt_pk_bf16_f32 v89, v226, v227
    s_waitcnt lgkmcnt(11)
    v_mfma_f32_32x32x16_bf16 v[240:255], v[116:119], v[48:51], v[240:255]
    v_cvt_pk_bf16_f32 v90, v228, v229
    v_cvt_pk_bf16_f32 v91, v230, v231
    v_cvt_pk_bf16_f32 v92, v232, v233
    v_cvt_pk_bf16_f32 v93, v234, v235
    s_waitcnt lgkmcnt(10)
    v_mfma_f32_32x32x16_bf16 v[176:191], v[120:123], v[52:55], v[176:191]
    v_cvt_pk_bf16_f32 v94, v236, v237
    v_cvt_pk_bf16_f32 v95, v238, v239
    ds_write_b128 v74, v[88:91] offset:8192
    ds_write_b128 v75, v[92:95] offset:8192
    s_waitcnt lgkmcnt(12)
    v_mfma_f32_32x32x16_bf16 v[240:255], v[124:127], v[52:55], v[240:255]
    ds_read_b128 v[32:35], v76 offset:8192
    ds_read_b128 v[36:39], v76 offset:9216
    ds_read_b128 v[56:59], v76 offset:10240
    ds_read_b128 v[60:63], v76 offset:11264
    s_waitcnt lgkmcnt(3)
    buffer_store_dwordx4 v[32:35], v77, s[40:43], s27 offen nt
    s_add_u32 s27, s27, 57344
    s_waitcnt lgkmcnt(2)
    buffer_store_dwordx4 v[36:39], v77, s[40:43], s27 offen nt
    s_add_u32 s27, s27, 57344
    s_waitcnt lgkmcnt(1)
    buffer_store_dwordx4 v[56:59], v77, s[40:43], s27 offen nt
    s_add_u32 s27, s27, 57344
    s_waitcnt lgkmcnt(0)
    buffer_store_dwordx4 v[60:63], v77, s[40:43], s27 offen nt
    s_add_u32 s27, s27, 57344
    s_nop 7
    v_cvt_pk_bf16_f32 v80, v176, v177
    v_cvt_pk_bf16_f32 v81, v178, v179
    v_cvt_pk_bf16_f32 v82, v180, v181
    v_cvt_pk_bf16_f32 v83, v182, v183
    v_cvt_pk_bf16_f32 v84, v184, v185
    v_cvt_pk_bf16_f32 v85, v186, v187
    v_cvt_pk_bf16_f32 v86, v188, v189
    v_cvt_pk_bf16_f32 v87, v190, v191
    ds_write_b128 v72, v[80:83] offset:12288
    ds_write_b128 v73, v[84:87] offset:12288
    v_cvt_pk_bf16_f32 v88, v240, v241
    v_cvt_pk_bf16_f32 v89, v242, v243
    v_cvt_pk_bf16_f32 v90, v244, v245
    v_cvt_pk_bf16_f32 v91, v246, v247
    v_cvt_pk_bf16_f32 v92, v248, v249
    v_cvt_pk_bf16_f32 v93, v250, v251
    v_cvt_pk_bf16_f32 v94, v252, v253
    v_cvt_pk_bf16_f32 v95, v254, v255
    ds_write_b128 v74, v[88:91] offset:12288
    ds_write_b128 v75, v[92:95] offset:12288
    ds_read_b128 v[32:35], v76 offset:12288
    ds_read_b128 v[36:39], v76 offset:13312
    ds_read_b128 v[56:59], v76 offset:14336
    ds_read_b128 v[60:63], v76 offset:15360
    s_waitcnt lgkmcnt(3)
    buffer_store_dwordx4 v[32:35], v77, s[40:43], s27 offen nt
    s_add_u32 s27, s27, 57344
    s_waitcnt lgkmcnt(2)
    buffer_store_dwordx4 v[36:39], v77, s[40:43], s27 offen nt
    s_add_u32 s27, s27, 57344
    s_waitcnt lgkmcnt(1)
    buffer_store_dwordx4 v[56:59], v77, s[40:43], s27 offen nt
    s_add_u32 s27, s27, 57344
    s_waitcnt lgkmcnt(0)
    buffer_store_dwordx4 v[60:63], v77, s[40:43], s27 offen nt
    s_add_u32 s27, s27, 57344
    s_endpgm
L_producer:
    s_sub_u32 s21, s18, 4
    v_lshrrev_b32 v9, 5, v7
    v_and_b32 v11, 31, v7
    s_lshl_b32 s22, s21, 1
    v_add_u32 v9, s22, v9
    v_mul_u32_u24 v2, 114688, v9
    v_lshl_add_u32 v2, v11, 4, v2
    s_mov_b32 s44, 14336
    s_mov_b32 s45, 28672
    s_mov_b32 s46, 43008
    s_mov_b32 s47, 57344
    s_mov_b32 s48, 71680
    s_mov_b32 s49, 86016
    s_mov_b32 s50, 100352
    s_mov_b32 s30, 903680
    s_mov_b32 s31, 0x20000
    s_lshl_b32 s22, s20, 9
    s_waitcnt lgkmcnt(0)
    s_mov_b32 s14, 0
    s_mov_b32 s15, 0
    s_add_u32 s8, s6, s22
    s_addc_u32 s9, s7, 0
    s_and_b32 s9, s9, 0xffff
    s_add_u32 s12, s93, s14
    s_and_b32 s12, s12, 7
    s_and_b32 s13, s14, 8
    s_or_b32 s12, s12, s13
    s_mul_i32 s12, s12, 917504
    s_add_u32 s28, s8, s12
    s_addc_u32 s29, s9, 0
    s_add_u32 s14, s14, 1
    buffer_load_dwordx4 v[128:131], v2, s[28:31], 0 offen
    buffer_load_dwordx4 v[132:135], v2, s[28:31], s44 offen
    buffer_load_dwordx4 v[136:139], v2, s[28:31], s45 offen
    buffer_load_dwordx4 v[140:143], v2, s[28:31], s46 offen
    buffer_load_dwordx4 v[144:147], v2, s[28:31], s47 offen
    buffer_load_dwordx4 v[148:151], v2, s[28:31], s48 offen
    buffer_load_dwordx4 v[152:155], v2, s[28:31], s49 offen
    buffer_load_dwordx4 v[156:159], v2, s[28:31], s50 offen
    s_add_u32 s12, s93, 0
    s_and_b32 s12, s12, 7
    s_mul_i32 s72, s12, 917504
    s_add_u32 s12, s93, 1
    s_and_b32 s12, s12, 7
    s_mul_i32 s73, s12, 917504
    s_add_u32 s12, s93, 2
    s_and_b32 s12, s12, 7
    s_mul_i32 s74, s12, 917504
    s_add_u32 s12, s93, 3
    s_and_b32 s12, s12, 7
    s_mul_i32 s75, s12, 917504
    s_add_u32 s12, s93, 4
    s_and_b32 s12, s12, 7
    s_mul_i32 s76, s12, 917504
    s_add_u32 s12, s93, 5
    s_and_b32 s12, s12, 7
    s_mul_i32 s77, s12, 917504
    s_add_u32 s12, s93, 6
    s_and_b32 s12, s12, 7
    s_mul_i32 s78, s12, 917504
    s_add_u32 s12, s93, 7
    s_and_b32 s12, s12, 7
    s_mul_i32 s79, s12, 917504
    s_add_u32 s12, s93, 0
    s_and_b32 s12, s12, 7
    s_or_b32 s12, s12, 8
    s_mul_i32 s80, s12, 917504
    s_add_u32 s12, s93, 1
    s_and_b32 s12, s12, 7
    s_or_b32 s12, s12, 8
    s_mul_i32 s81, s12, 917504
    s_add_u32 s12, s93, 2
    s_and_b32 s12, s12, 7
    s_or_b32 s12, s12, 8
    s_mul_i32 s82, s12, 917504
    s_add_u32 s12, s93, 3
    s_and_b32 s12, s12, 7
    s_or_b32 s12, s12, 8
    s_mul_i32 s83, s12, 917504
    s_add_u32 s12, s93, 4
    s_and_b32 s12, s12, 7
    s_or_b32 s12, s12, 8
    s_mul_i32 s84, s12, 917504
    s_add_u32 s12, s93, 5
    s_and_b32 s12, s12, 7
    s_or_b32 s12, s12, 8
    s_mul_i32 s85, s12, 917504
    s_add_u32 s12, s93, 6
    s_and_b32 s12, s12, 7
    s_or_b32 s12, s12, 8
    s_mul_i32 s86, s12, 917504
    s_add_u32 s12, s93, 7
    s_and_b32 s12, s12, 7
    s_or_b32 s12, s12, 8
    s_mul_i32 s87, s12, 917504
    s_mov_b32 s88, 0
    s_mov_b32 m0, s14
    v_and_b32 v12, 3, v11
    v_bfe_u32 v13, v11, 2, 1
    v_lshrrev_b32 v14, 3, v11
    v_lshlrev_b32 v14, 5, v14
    v_lshl_add_u32 v14, v12, 3, v14
    v_lshl_add_u32 v14, v13, 2, v14
    v_lshl_or_b32 v12, v13, 2, v12
    v_xor_b32 v12, v12, v9
    v_lshlrev_b32 v12, 4, v12
    v_lshl_add_u32 v5, v14, 7, v12
    v_add_u32 v5, 98304, v5
    v_xor_b32 v6, 64, v5
    v_lshlrev_b32 v3, 4, v11
    v_add_u32 v3, 131072, v3
    v_lshlrev_b32 v4, 5, v9
    v_add_u32 v4, 147456, v4
    s_mov_b32 s92, 0
    s_barrier
    s_movrels_b32 s12, s72
    s_add_u32 s14, s14, 1
    s_add_u32 s28, s8, s12
    s_addc_u32 s29, s9, 0
    s_mov_b32 m0, s14
    buffer_load_dwordx4 v[160:163], v2, s[28:31], 0 offen
    buffer_load_dwordx4 v[164:167], v2, s[28:31], s44 offen
    buffer_load_dwordx4 v[168:171], v2, s[28:31], s45 offen
    buffer_load_dwordx4 v[172:175], v2, s[28:31], s46 offen
    buffer_load_dwordx4 v[176:179], v2, s[28:31], s47 offen
    buffer_load_dwordx4 v[180:183], v2, s[28:31], s48 offen
    buffer_load_dwordx4 v[184:187], v2, s[28:31], s49 offen
    buffer_load_dwordx4 v[188:191], v2, s[28:31], s50 offen
    ds_read_b128 v[16:19], v3 offset:0
    ds_read_b128 v[20:23], v3 offset:8192
    ds_read_b128 v[24:27], v4 offset:0
    ds_read_b128 v[28:31], v4 offset:16
    s_nop 0
    ds_read_b128 v[32:35], v3 offset:512
    ds_read_b128 v[36:39], v3 offset:8704
    ds_read_b128 v[40:43], v4 offset:256
    ds_read_b128 v[44:47], v4 offset:272
    s_waitcnt lgkmcnt(4)
    s_waitcnt vmcnt(8)
    v_cvt_f32_i32 v48, v128
    v_cvt_f32_i32 v49, v132
    v_cvt_f32_i32 v50, v136
    v_cvt_f32_i32 v51, v140
    v_cvt_f32_i32 v52, v144
    v_cvt_f32_i32 v53, v148
    v_cvt_f32_i32 v54, v152
    v_cvt_f32_i32 v55, v156
    v_fma_f32 v48, v48, v16, v20
    v_fma_f32 v49, v49, v16, v20
    v_fma_f32 v50, v50, v16, v20
    v_fma_f32 v51, v51, v16, v20
    v_fma_f32 v52, v52, v16, v20
    v_fma_f32 v53, v53, v16, v20
    v_fma_f32 v54, v54, v16, v20
    v_fma_f32 v55, v55, v16, v20
    v_mul_f32 v48, v48, v24
    v_mul_f32 v49, v49, v25
    v_mul_f32 v50, v50, v26
    v_mul_f32 v51, v51, v27
    v_mul_f32 v52, v52, v28
    v_mul_f32 v53, v53, v29
    v_mul_f32 v54, v54, v30
    v_mul_f32 v55, v55, v31
    v_cvt_pk_bf16_f32 v64, v48, v49
    v_cvt_pk_bf16_f32 v65, v50, v51
    v_cvt_pk_bf16_f32 v66, v52, v53
    v_cvt_pk_bf16_f32 v67, v54, v55
    ds_write_b128 v5, v[64:67] offset:0
    v_cvt_f32_i32 v56, v129
    v_cvt_f32_i32 v57, v133
    v_cvt_f32_i32 v58, v137
    v_cvt_f32_i32 v59, v141
    v_cvt_f32_i32 v60, v145
    v_cvt_f32_i32 v61, v149
    v_cvt_f32_i32 v62, v153
    v_cvt_f32_i32 v63, v157
    v_fma_f32 v56, v56, v17, v21
    v_fma_f32 v57, v57, v17, v21
    v_fma_f32 v58, v58, v17, v21
    v_fma_f32 v59, v59, v17, v21
    v_fma_f32 v60, v60, v17, v21
    v_fma_f32 v61, v61, v17, v21
    v_fma_f32 v62, v62, v17, v21
    v_fma_f32 v63, v63, v17, v21
    v_mul_f32 v56, v56, v24
    v_mul_f32 v57, v57, v25
    v_mul_f32 v58, v58, v26
    v_mul_f32 v59, v59, v27
    v_mul_f32 v60, v60, v28
    v_mul_f32 v61, v61, v29
    v_mul_f32 v62, v62, v30
    v_mul_f32 v63, v63, v31
    v_cvt_pk_bf16_f32 v68, v56, v57
    v_cvt_pk_bf16_f32 v69, v58, v59
    v_cvt_pk_bf16_f32 v70, v60, v61
    v_cvt_pk_bf16_f32 v71, v62, v63
    ds_write_b128 v5, v[68:71] offset:128
    v_cvt_f32_i32 v48, v130
    v_cvt_f32_i32 v49, v134
    v_cvt_f32_i32 v50, v138
    v_cvt_f32_i32 v51, v142
    v_cvt_f32_i32 v52, v146
    v_cvt_f32_i32 v53, v150
    v_cvt_f32_i32 v54, v154
    v_cvt_f32_i32 v55, v158
    v_fma_f32 v48, v48, v18, v22
    v_fma_f32 v49, v49, v18, v22
    v_fma_f32 v50, v50, v18, v22
    v_fma_f32 v51, v51, v18, v22
    v_fma_f32 v52, v52, v18, v22
    v_fma_f32 v53, v53, v18, v22
    v_fma_f32 v54, v54, v18, v22
    v_fma_f32 v55, v55, v18, v22
    v_mul_f32 v48, v48, v24
    v_mul_f32 v49, v49, v25
    v_mul_f32 v50, v50, v26
    v_mul_f32 v51, v51, v27
    v_mul_f32 v52, v52, v28
    v_mul_f32 v53, v53, v29
    v_mul_f32 v54, v54, v30
    v_mul_f32 v55, v55, v31
    v_cvt_pk_bf16_f32 v72, v48, v49
    v_cvt_pk_bf16_f32 v73, v50, v51
    v_cvt_pk_bf16_f32 v74, v52, v53
    v_cvt_pk_bf16_f32 v75, v54, v55
    ds_write_b128 v6, v[72:75] offset:256
    v_cvt_f32_i32 v56, v131
    v_cvt_f32_i32 v57, v135
    v_cvt_f32_i32 v58, v139
    v_cvt_f32_i32 v59, v143
    v_cvt_f32_i32 v60, v147
    v_cvt_f32_i32 v61, v151
    v_cvt_f32_i32 v62, v155
    v_cvt_f32_i32 v63, v159
    v_fma_f32 v56, v56, v19, v23
    v_fma_f32 v57, v57, v19, v23
    v_fma_f32 v58, v58, v19, v23
    v_fma_f32 v59, v59, v19, v23
    v_fma_f32 v60, v60, v19, v23
    v_fma_f32 v61, v61, v19, v23
    v_fma_f32 v62, v62, v19, v23
    v_fma_f32 v63, v63, v19, v23
    v_mul_f32 v56, v56, v24
    v_mul_f32 v57, v57, v25
    v_mul_f32 v58, v58, v26
    v_mul_f32 v59, v59, v27
    v_mul_f32 v60, v60, v28
    v_mul_f32 v61, v61, v29
    v_mul_f32 v62, v62, v30
    v_mul_f32 v63, v63, v31
    v_cvt_pk_bf16_f32 v76, v56, v57
    v_cvt_pk_bf16_f32 v77, v58, v59
    v_cvt_pk_bf16_f32 v78, v60, v61
    v_cvt_pk_bf16_f32 v79, v62, v63
    ds_write_b128 v6, v[76:79] offset:384
    s_waitcnt lgkmcnt(0)
    s_barrier
    ds_read_b128 v[16:19], v3 offset:1024
    ds_read_b128 v[20:23], v3 offset:9216
    ds_read_b128 v[24:27], v4 offset:512
    ds_read_b128 v[28:31], v4 offset:528
    v_add_u32 v3, 1536, v3
    v_add_u32 v4, 768, v4
    s_waitcnt vmcnt(0)
    v_cvt_f32_i32 v48, v160
    v_cvt_f32_i32 v49, v164
    v_cvt_f32_i32 v50, v168
    v_cvt_f32_i32 v51, v172
    s_movrels_b32 s12, s72
    s_add_u32 s14, s14, 1
    s_add_u32 s28, s8, s12
    s_addc_u32 s29, s9, 0
    s_mov_b32 m0, s14
    buffer_load_dwordx4 v[192:195], v2, s[28:31], 0 offen
    v_cvt_f32_i32 v52, v176
    v_cvt_f32_i32 v53, v180
    v_cvt_f32_i32 v54, v184
    v_cvt_f32_i32 v55, v188
    v_fma_f32 v48, v48, v32, v36
    v_fma_f32 v49, v49, v32, v36
    v_fma_f32 v50, v50, v32, v36
    v_fma_f32 v51, v51, v32, v36
    v_fma_f32 v52, v52, v32, v36
    v_fma_f32 v53, v53, v32, v36
    v_fma_f32 v54, v54, v32, v36
    v_fma_f32 v55, v55, v32, v36
    buffer_load_dwordx4 v[196:199], v2, s[28:31], s44 offen
    v_mul_f32 v48, v48, v40
    v_mul_f32 v49, v49, v41
    v_mul_f32 v50, v50, v42
    v_mul_f32 v51, v51, v43
    v_mul_f32 v52, v52, v44
    v_mul_f32 v53, v53, v45
    v_mul_f32 v54, v54, v46
    v_mul_f32 v55, v55, v47
    buffer_load_dwordx4 v[200:203], v2, s[28:31], s45 offen
    v_cvt_pk_bf16_f32 v64, v48, v49
    v_cvt_pk_bf16_f32 v65, v50, v51
    v_cvt_pk_bf16_f32 v66, v52, v53
    v_cvt_pk_bf16_f32 v67, v54, v55
    ds_write_b128 v5, v[64:67] offset:16384
    buffer_load_dwordx4 v[204:207], v2, s[28:31], s46 offen
    v_cvt_f32_i32 v56, v161
    v_cvt_f32_i32 v57, v165
    v_cvt_f32_i32 v58, v169
    v_cvt_f32_i32 v59, v173
    v_cvt_f32_i32 v60, v177
    v_cvt_f32_i32 v61, v181
    v_cvt_f32_i32 v62, v185
    v_cvt_f32_i32 v63, v189
    v_fma_f32 v56, v56, v33, v37
    v_fma_f32 v57, v57, v33, v37
    v_fma_f32 v58, v58, v33, v37
    v_fma_f32 v59, v59, v33, v37
    v_fma_f32 v60, v60, v33, v37
    v_fma_f32 v61, v61, v33, v37
    v_fma_f32 v62, v62, v33, v37
    v_fma_f32 v63, v63, v33, v37
    buffer_load_dwordx4 v[208:211], v2, s[28:31], s47 offen
    v_mul_f32 v56, v56, v40
    v_mul_f32 v57, v57, v41
    v_mul_f32 v58, v58, v42
    v_mul_f32 v59, v59, v43
    v_mul_f32 v60, v60, v44
    v_mul_f32 v61, v61, v45
    v_mul_f32 v62, v62, v46
    v_mul_f32 v63, v63, v47
    buffer_load_dwordx4 v[212:215], v2, s[28:31], s48 offen
    v_cvt_pk_bf16_f32 v68, v56, v57
    v_cvt_pk_bf16_f32 v69, v58, v59
    v_cvt_pk_bf16_f32 v70, v60, v61
    v_cvt_pk_bf16_f32 v71, v62, v63
    ds_write_b128 v5, v[68:71] offset:16512
    buffer_load_dwordx4 v[216:219], v2, s[28:31], s49 offen
    v_cvt_f32_i32 v48, v162
    v_cvt_f32_i32 v49, v166
    v_cvt_f32_i32 v50, v170
    v_cvt_f32_i32 v51, v174
    buffer_load_dwordx4 v[220:223], v2, s[28:31], s50 offen
    v_cvt_f32_i32 v52, v178
    v_cvt_f32_i32 v53, v182
    v_cvt_f32_i32 v54, v186
    v_cvt_f32_i32 v55, v190
    v_fma_f32 v48, v48, v34, v38
    v_fma_f32 v49, v49, v34, v38
    v_fma_f32 v50, v50, v34, v38
    v_fma_f32 v51, v51, v34, v38
    v_fma_f32 v52, v52, v34, v38
    v_fma_f32 v53, v53, v34, v38
    v_fma_f32 v54, v54, v34, v38
    v_fma_f32 v55, v55, v34, v38
    v_mul_f32 v48, v48, v40
    v_mul_f32 v49, v49, v41
    v_mul_f32 v50, v50, v42
    v_mul_f32 v51, v51, v43
    v_mul_f32 v52, v52, v44
    v_mul_f32 v53, v53, v45
    v_mul_f32 v54, v54, v46
    v_mul_f32 v55, v55, v47
    s_movrels_b32 s12, s72
    s_add_u32 s14, s14, 1
    s_add_u32 s28, s8, s12
    s_addc_u32 s29, s9, 0
    s_mov_b32 m0, s14
    s_nop 0
    buffer_load_dwordx4 v[224:227], v2, s[28:31], 0 offen
    v_cvt_pk_bf16_f32 v72, v48, v49
    v_cvt_pk_bf16_f32 v73, v50, v51
    v_cvt_pk_bf16_f32 v74, v52, v53
    v_cvt_pk_bf16_f32 v75, v54, v55
    ds_write_b128 v6, v[72:75] offset:16640
    buffer_load_dwordx4 v[228:231], v2, s[28:31], s44 offen
    v_cvt_f32_i32 v56, v163
    v_cvt_f32_i32 v57, v167
    v_cvt_f32_i32 v58, v171
    v_cvt_f32_i32 v59, v175
    buffer_load_dwordx4 v[232:235], v2, s[28:31], s45 offen
    v_cvt_f32_i32 v60, v179
    v_cvt_f32_i32 v61, v183
    v_cvt_f32_i32 v62, v187
    v_cvt_f32_i32 v63, v191
    v_fma_f32 v56, v56, v35, v39
    v_fma_f32 v57, v57, v35, v39
    v_fma_f32 v58, v58, v35, v39
    v_fma_f32 v59, v59, v35, v39
    v_fma_f32 v60, v60, v35, v39
    v_fma_f32 v61, v61, v35, v39
    v_fma_f32 v62, v62, v35, v39
    v_fma_f32 v63, v63, v35, v39
    buffer_load_dwordx4 v[236:239], v2, s[28:31], s46 offen
    v_mul_f32 v56, v56, v40
    v_mul_f32 v57, v57, v41
    v_mul_f32 v58, v58, v42
    v_mul_f32 v59, v59, v43
    v_mul_f32 v60, v60, v44
    v_mul_f32 v61, v61, v45
    v_mul_f32 v62, v62, v46
    v_mul_f32 v63, v63, v47
    v_cvt_pk_bf16_f32 v76, v56, v57
    v_cvt_pk_bf16_f32 v77, v58, v59
    v_cvt_pk_bf16_f32 v78, v60, v61
    v_cvt_pk_bf16_f32 v79, v62, v63
    ds_write_b128 v6, v[76:79] offset:16768
    buffer_load_dwordx4 v[240:243], v2, s[28:31], s47 offen
    buffer_load_dwordx4 v[244:247], v2, s[28:31], s48 offen
    buffer_load_dwordx4 v[248:251], v2, s[28:31], s49 offen
    buffer_load_dwordx4 v[252:255], v2, s[28:31], s50 offen
    s_waitcnt lgkmcnt(0)
    s_barrier
.p2align 6
L_ploop:
    ds_read_b128 v[32:35], v3 offset:0
    ds_read_b128 v[36:39], v3 offset:8192
    ds_read_b128 v[40:43], v4 offset:0
    ds_read_b128 v[44:47], v4 offset:16
    s_waitcnt vmcnt(8)
    v_cvt_f32_i32 v48, v192
    v_cvt_f32_i32 v49, v196
    v_cvt_f32_i32 v50, v200
    v_cvt_f32_i32 v51, v204
    s_movrels_b32 s12, s72
    s_add_u32 s14, s14, 1
    s_add_u32 s28, s8, s12
    s_addc_u32 s29, s9, 0
    s_mov_b32 m0, s14
    buffer_load_dwordx4 v[128:131], v2, s[28:31], 0 offen
    v_cvt_f32_i32 v52, v208
    v_cvt_f32_i32 v53, v212
    v_cvt_f32_i32 v54, v216
    v_cvt_f32_i32 v55, v220
    v_fma_f32 v48, v48, v16, v20
    v_fma_f32 v49, v49, v16, v20
    v_fma_f32 v50, v50, v16, v20
    v_fma_f32 v51, v51, v16, v20
    v_fma_f32 v52, v52, v16, v20
    v_fma_f32 v53, v53, v16, v20
    v_fma_f32 v54, v54, v16, v20
    v_fma_f32 v55, v55, v16, v20
    v_mul_f32 v48, v48, v24
    v_mul_f32 v49, v49, v25
    v_mul_f32 v50, v50, v26
    v_mul_f32 v51, v51, v27
    v_mul_f32 v52, v52, v28
    v_mul_f32 v53, v53, v29
    v_mul_f32 v54, v54, v30
    v_mul_f32 v55, v55, v31
    buffer_load_dwordx4 v[132:135], v2, s[28:31], s44 offen
    v_cvt_pk_bf16_f32 v64, v48, v49
    v_cvt_pk_bf16_f32 v65, v50, v51
    v_cvt_pk_bf16_f32 v66, v52, v53
    v_cvt_pk_bf16_f32 v67, v54, v55
    ds_write_b128 v5, v[64:67] offset:0
    v_cvt_f32_i32 v56, v193
    v_cvt_f32_i32 v57, v197
    v_cvt_f32_i32 v58, v201
    v_cvt_f32_i32 v59, v205
    v_cvt_f32_i32 v60, v209
    v_cvt_f32_i32 v61, v213
    v_cvt_f32_i32 v62, v217
    v_cvt_f32_i32 v63, v221
    v_fma_f32 v56, v56, v17, v21
    v_fma_f32 v57, v57, v17, v21
    v_fma_f32 v58, v58, v17, v21
    v_fma_f32 v59, v59, v17, v21
    v_fma_f32 v60, v60, v17, v21
    v_fma_f32 v61, v61, v17, v21
    v_fma_f32 v62, v62, v17, v21
    v_fma_f32 v63, v63, v17, v21
    buffer_load_dwordx4 v[136:139], v2, s[28:31], s45 offen
    v_mul_f32 v56, v56, v24
    v_mul_f32 v57, v57, v25
    v_mul_f32 v58, v58, v26
    v_mul_f32 v59, v59, v27
    v_mul_f32 v60, v60, v28
    v_mul_f32 v61, v61, v29
    v_mul_f32 v62, v62, v30
    v_mul_f32 v63, v63, v31
    v_cvt_pk_bf16_f32 v68, v56, v57
    v_cvt_pk_bf16_f32 v69, v58, v59
    v_cvt_pk_bf16_f32 v70, v60, v61
    v_cvt_pk_bf16_f32 v71, v62, v63
    ds_write_b128 v5, v[68:71] offset:128
    buffer_load_dwordx4 v[140:143], v2, s[28:31], s46 offen
    v_cvt_f32_i32 v48, v194
    v_cvt_f32_i32 v49, v198
    v_cvt_f32_i32 v50, v202
    v_cvt_f32_i32 v51, v206
    v_cvt_f32_i32 v52, v210
    v_cvt_f32_i32 v53, v214
    v_cvt_f32_i32 v54, v218
    v_cvt_f32_i32 v55, v222
    v_fma_f32 v48, v48, v18, v22
    v_fma_f32 v49, v49, v18, v22
    v_fma_f32 v50, v50, v18, v22
    v_fma_f32 v51, v51, v18, v22
    v_fma_f32 v52, v52, v18, v22
    v_fma_f32 v53, v53, v18, v22
    v_fma_f32 v54, v54, v18, v22
    v_fma_f32 v55, v55, v18, v22
    v_mul_f32 v48, v48, v24
    v_mul_f32 v49, v49, v25
    v_mul_f32 v50, v50, v26
    v_mul_f32 v51, v51, v27
    v_mul_f32 v52, v52, v28
    v_mul_f32 v53, v53, v29
    v_mul_f32 v54, v54, v30
    v_mul_f32 v55, v55, v31
    buffer_load_dwordx4 v[144:147], v2, s[28:31], s47 offen
    v_cvt_pk_bf16_f32 v72, v48, v49
    v_cvt_pk_bf16_f32 v73, v50, v51
    v_cvt_pk_bf16_f32 v74, v52, v53
    v_cvt_pk_bf16_f32 v75, v54, v55
    ds_write_b128 v6, v[72:75] offset:256
    v_cvt_f32_i32 v56, v195
    v_cvt_f32_i32 v57, v199
    v_cvt_f32_i32 v58, v203
    v_cvt_f32_i32 v59, v207
    buffer_load_dwordx4 v[148:151], v2, s[28:31], s48 offen
    v_cvt_f32_i32 v60, v211
    v_cvt_f32_i32 v61, v215
    v_cvt_f32_i32 v62, v219
    v_cvt_f32_i32 v63, v223
    v_fma_f32 v56, v56, v19, v23
    v_fma_f32 v57, v57, v19, v23
    v_fma_f32 v58, v58, v19, v23
    v_fma_f32 v59, v59, v19, v23
    v_fma_f32 v60, v60, v19, v23
    v_fma_f32 v61, v61, v19, v23
    v_fma_f32 v62, v62, v19, v23
    v_fma_f32 v63, v63, v19, v23
    v_mul_f32 v56, v56, v24
    v_mul_f32 v57, v57, v25
    v_mul_f32 v58, v58, v26
    v_mul_f32 v59, v59, v27
    v_mul_f32 v60, v60, v28
    v_mul_f32 v61, v61, v29
    v_mul_f32 v62, v62, v30
    v_mul_f32 v63, v63, v31
    v_cvt_pk_bf16_f32 v76, v56, v57
    v_cvt_pk_bf16_f32 v77, v58, v59
    v_cvt_pk_bf16_f32 v78, v60, v61
    v_cvt_pk_bf16_f32 v79, v62, v63
    ds_write_b128 v6, v[76:79] offset:384
    buffer_load_dwordx4 v[152:155], v2, s[28:31], s49 offen
    buffer_load_dwordx4 v[156:159], v2, s[28:31], s50 offen
    s_waitcnt lgkmcnt(0)
    s_barrier
    ds_read_b128 v[16:19], v3 offset:512
    ds_read_b128 v[20:23], v3 offset:8704
    ds_read_b128 v[24:27], v4 offset:256
    ds_read_b128 v[28:31], v4 offset:272
    s_waitcnt vmcnt(8)
    v_cvt_f32_i32 v48, v224
    v_cvt_f32_i32 v49, v228
    v_cvt_f32_i32 v50, v232
    v_cvt_f32_i32 v51, v236
    s_movrels_b32 s12, s72
    s_add_u32 s14, s14, 1
    s_add_u32 s28, s8, s12
    s_addc_u32 s29, s9, 0
    s_mov_b32 m0, s14
    buffer_load_dwordx4 v[160:163], v2, s[28:31], 0 offen
    v_cvt_f32_i32 v52, v240
    v_cvt_f32_i32 v53, v244
    v_cvt_f32_i32 v54, v248
    v_cvt_f32_i32 v55, v252
    v_fma_f32 v48, v48, v32, v36
    v_fma_f32 v49, v49, v32, v36
    v_fma_f32 v50, v50, v32, v36
    v_fma_f32 v51, v51, v32, v36
    v_fma_f32 v52, v52, v32, v36
    v_fma_f32 v53, v53, v32, v36
    v_fma_f32 v54, v54, v32, v36
    v_fma_f32 v55, v55, v32, v36
    v_mul_f32 v48, v48, v40
    v_mul_f32 v49, v49, v41
    v_mul_f32 v50, v50, v42
    v_mul_f32 v51, v51, v43
    v_mul_f32 v52, v52, v44
    v_mul_f32 v53, v53, v45
    v_mul_f32 v54, v54, v46
    v_mul_f32 v55, v55, v47
    buffer_load_dwordx4 v[164:167], v2, s[28:31], s44 offen
    v_cvt_pk_bf16_f32 v64, v48, v49
    v_cvt_pk_bf16_f32 v65, v50, v51
    v_cvt_pk_bf16_f32 v66, v52, v53
    v_cvt_pk_bf16_f32 v67, v54, v55
    ds_write_b128 v5, v[64:67] offset:16384
    v_cvt_f32_i32 v56, v225
    v_cvt_f32_i32 v57, v229
    v_cvt_f32_i32 v58, v233
    v_cvt_f32_i32 v59, v237
    v_cvt_f32_i32 v60, v241
    v_cvt_f32_i32 v61, v245
    v_cvt_f32_i32 v62, v249
    v_cvt_f32_i32 v63, v253
    v_fma_f32 v56, v56, v33, v37
    v_fma_f32 v57, v57, v33, v37
    v_fma_f32 v58, v58, v33, v37
    v_fma_f32 v59, v59, v33, v37
    v_fma_f32 v60, v60, v33, v37
    v_fma_f32 v61, v61, v33, v37
    v_fma_f32 v62, v62, v33, v37
    v_fma_f32 v63, v63, v33, v37
    buffer_load_dwordx4 v[168:171], v2, s[28:31], s45 offen
    v_mul_f32 v56, v56, v40
    v_mul_f32 v57, v57, v41
    v_mul_f32 v58, v58, v42
    v_mul_f32 v59, v59, v43
    v_mul_f32 v60, v60, v44
    v_mul_f32 v61, v61, v45
    v_mul_f32 v62, v62, v46
    v_mul_f32 v63, v63, v47
    v_cvt_pk_bf16_f32 v68, v56, v57
    v_cvt_pk_bf16_f32 v69, v58, v59
    v_cvt_pk_bf16_f32 v70, v60, v61
    v_cvt_pk_bf16_f32 v71, v62, v63
    ds_write_b128 v5, v[68:71] offset:16512
    buffer_load_dwordx4 v[172:175], v2, s[28:31], s46 offen
    v_cvt_f32_i32 v48, v226
    v_cvt_f32_i32 v49, v230
    v_cvt_f32_i32 v50, v234
    v_cvt_f32_i32 v51, v238
    v_cvt_f32_i32 v52, v242
    v_cvt_f32_i32 v53, v246
    v_cvt_f32_i32 v54, v250
    v_cvt_f32_i32 v55, v254
    v_fma_f32 v48, v48, v34, v38
    v_fma_f32 v49, v49, v34, v38
    v_fma_f32 v50, v50, v34, v38
    v_fma_f32 v51, v51, v34, v38
    v_fma_f32 v52, v52, v34, v38
    v_fma_f32 v53, v53, v34, v38
    v_fma_f32 v54, v54, v34, v38
    v_fma_f32 v55, v55, v34, v38
    v_mul_f32 v48, v48, v40
    v_mul_f32 v49, v49, v41
    v_mul_f32 v50, v50, v42
    v_mul_f32 v51, v51, v43
    v_mul_f32 v52, v52, v44
    v_mul_f32 v53, v53, v45
    v_mul_f32 v54, v54, v46
    v_mul_f32 v55, v55, v47
    buffer_load_dwordx4 v[176:179], v2, s[28:31], s47 offen
    v_cvt_pk_bf16_f32 v72, v48, v49
    v_cvt_pk_bf16_f32 v73, v50, v51
    v_cvt_pk_bf16_f32 v74, v52, v53
    v_cvt_pk_bf16_f32 v75, v54, v55
    ds_write_b128 v6, v[72:75] offset:16640
    v_cvt_f32_i32 v56, v227
    v_cvt_f32_i32 v57, v231
    v_cvt_f32_i32 v58, v235
    v_cvt_f32_i32 v59, v239
    buffer_load_dwordx4 v[180:183], v2, s[28:31], s48 offen
    v_cvt_f32_i32 v60, v243
    v_cvt_f32_i32 v61, v247
    v_cvt_f32_i32 v62, v251
    v_cvt_f32_i32 v63, v255
    v_fma_f32 v56, v56, v35, v39
    v_fma_f32 v57, v57, v35, v39
    v_fma_f32 v58, v58, v35, v39
    v_fma_f32 v59, v59, v35, v39
    v_fma_f32 v60, v60, v35, v39
    v_fma_f32 v61, v61, v35, v39
    v_fma_f32 v62, v62, v35, v39
    v_fma_f32 v63, v63, v35, v39
    v_mul_f32 v56, v56, v40
    v_mul_f32 v57, v57, v41
    v_mul_f32 v58, v58, v42
    v_mul_f32 v59, v59, v43
    v_mul_f32 v60, v60, v44
    v_mul_f32 v61, v61, v45
    v_mul_f32 v62, v62, v46
    v_mul_f32 v63, v63, v47
    v_cvt_pk_bf16_f32 v76, v56, v57
    v_cvt_pk_bf16_f32 v77, v58, v59
    v_cvt_pk_bf16_f32 v78, v60, v61
    v_cvt_pk_bf16_f32 v79, v62, v63
    ds_write_b128 v6, v[76:79] offset:16768
    buffer_load_dwordx4 v[184:187], v2, s[28:31], s49 offen
    buffer_load_dwordx4 v[188:191], v2, s[28:31], s50 offen
    s_waitcnt lgkmcnt(0)
    s_barrier
    ds_read_b128 v[32:35], v3 offset:1024
    ds_read_b128 v[36:39], v3 offset:9216
    ds_read_b128 v[40:43], v4 offset:512
    ds_read_b128 v[44:47], v4 offset:528
    s_waitcnt vmcnt(8)
    v_cvt_f32_i32 v48, v128
    v_cvt_f32_i32 v49, v132
    v_cvt_f32_i32 v50, v136
    v_cvt_f32_i32 v51, v140
    s_movrels_b32 s12, s72
    s_add_u32 s14, s14, 1
    s_add_u32 s28, s8, s12
    s_addc_u32 s29, s9, 0
    s_mov_b32 m0, s14
    buffer_load_dwordx4 v[192:195], v2, s[28:31], 0 offen
    v_cvt_f32_i32 v52, v144
    v_cvt_f32_i32 v53, v148
    v_cvt_f32_i32 v54, v152
    v_cvt_f32_i32 v55, v156
    v_fma_f32 v48, v48, v16, v20
    v_fma_f32 v49, v49, v16, v20
    v_fma_f32 v50, v50, v16, v20
    v_fma_f32 v51, v51, v16, v20
    v_fma_f32 v52, v52, v16, v20
    v_fma_f32 v53, v53, v16, v20
    v_fma_f32 v54, v54, v16, v20
    v_fma_f32 v55, v55, v16, v20
    v_mul_f32 v48, v48, v24
    v_mul_f32 v49, v49, v25
    v_mul_f32 v50, v50, v26
    v_mul_f32 v51, v51, v27
    v_mul_f32 v52, v52, v28
    v_mul_f32 v53, v53, v29
    v_mul_f32 v54, v54, v30
    v_mul_f32 v55, v55, v31
    buffer_load_dwordx4 v[196:199], v2, s[28:31], s44 offen
    v_cvt_pk_bf16_f32 v64, v48, v49
    v_cvt_pk_bf16_f32 v65, v50, v51
    v_cvt_pk_bf16_f32 v66, v52, v53
    v_cvt_pk_bf16_f32 v67, v54, v55
    ds_write_b128 v5, v[64:67] offset:0
    v_cvt_f32_i32 v56, v129
    v_cvt_f32_i32 v57, v133
    v_cvt_f32_i32 v58, v137
    v_cvt_f32_i32 v59, v141
    v_cvt_f32_i32 v60, v145
    v_cvt_f32_i32 v61, v149
    v_cvt_f32_i32 v62, v153
    v_cvt_f32_i32 v63, v157
    v_fma_f32 v56, v56, v17, v21
    v_fma_f32 v57, v57, v17, v21
    v_fma_f32 v58, v58, v17, v21
    v_fma_f32 v59, v59, v17, v21
    v_fma_f32 v60, v60, v17, v21
    v_fma_f32 v61, v61, v17, v21
    v_fma_f32 v62, v62, v17, v21
    v_fma_f32 v63, v63, v17, v21
    buffer_load_dwordx4 v[200:203], v2, s[28:31], s45 offen
    v_mul_f32 v56, v56, v24
    v_mul_f32 v57, v57, v25
    v_mul_f32 v58, v58, v26
    v_mul_f32 v59, v59, v27
    v_mul_f32 v60, v60, v28
    v_mul_f32 v61, v61, v29
    v_mul_f32 v62, v62, v30
    v_mul_f32 v63, v63, v31
    v_cvt_pk_bf16_f32 v68, v56, v57
    v_cvt_pk_bf16_f32 v69, v58, v59
    v_cvt_pk_bf16_f32 v70, v60, v61
    v_cvt_pk_bf16_f32 v71, v62, v63
    ds_write_b128 v5, v[68:71] offset:128
    buffer_load_dwordx4 v[204:207], v2, s[28:31], s46 offen
    v_cvt_f32_i32 v48, v130
    v_cvt_f32_i32 v49, v134
    v_cvt_f32_i32 v50, v138
    v_cvt_f32_i32 v51, v142
    v_cvt_f32_i32 v52, v146
    v_cvt_f32_i32 v53, v150
    v_cvt_f32_i32 v54, v154
    v_cvt_f32_i32 v55, v158
    v_fma_f32 v48, v48, v18, v22
    v_fma_f32 v49, v49, v18, v22
    v_fma_f32 v50, v50, v18, v22
    v_fma_f32 v51, v51, v18, v22
    v_fma_f32 v52, v52, v18, v22
    v_fma_f32 v53, v53, v18, v22
    v_fma_f32 v54, v54, v18, v22
    v_fma_f32 v55, v55, v18, v22
    v_mul_f32 v48, v48, v24
    v_mul_f32 v49, v49, v25
    v_mul_f32 v50, v50, v26
    v_mul_f32 v51, v51, v27
    v_mul_f32 v52, v52, v28
    v_mul_f32 v53, v53, v29
    v_mul_f32 v54, v54, v30
    v_mul_f32 v55, v55, v31
    buffer_load_dwordx4 v[208:211], v2, s[28:31], s47 offen
    v_cvt_pk_bf16_f32 v72, v48, v49
    v_cvt_pk_bf16_f32 v73, v50, v51
    v_cvt_pk_bf16_f32 v74, v52, v53
    v_cvt_pk_bf16_f32 v75, v54, v55
    ds_write_b128 v6, v[72:75] offset:256
    v_cvt_f32_i32 v56, v131
    v_cvt_f32_i32 v57, v135
    v_cvt_f32_i32 v58, v139
    v_cvt_f32_i32 v59, v143
    buffer_load_dwordx4 v[212:215], v2, s[28:31], s48 offen
    v_cvt_f32_i32 v60, v147
    v_cvt_f32_i32 v61, v151
    v_cvt_f32_i32 v62, v155
    v_cvt_f32_i32 v63, v159
    v_fma_f32 v56, v56, v19, v23
    v_fma_f32 v57, v57, v19, v23
    v_fma_f32 v58, v58, v19, v23
    v_fma_f32 v59, v59, v19, v23
    v_fma_f32 v60, v60, v19, v23
    v_fma_f32 v61, v61, v19, v23
    v_fma_f32 v62, v62, v19, v23
    v_fma_f32 v63, v63, v19, v23
    v_mul_f32 v56, v56, v24
    v_mul_f32 v57, v57, v25
    v_mul_f32 v58, v58, v26
    v_mul_f32 v59, v59, v27
    v_mul_f32 v60, v60, v28
    v_mul_f32 v61, v61, v29
    v_mul_f32 v62, v62, v30
    v_mul_f32 v63, v63, v31
    v_cvt_pk_bf16_f32 v76, v56, v57
    v_cvt_pk_bf16_f32 v77, v58, v59
    v_cvt_pk_bf16_f32 v78, v60, v61
    v_cvt_pk_bf16_f32 v79, v62, v63
    ds_write_b128 v6, v[76:79] offset:384
    buffer_load_dwordx4 v[216:219], v2, s[28:31], s49 offen
    buffer_load_dwordx4 v[220:223], v2, s[28:31], s50 offen
    s_waitcnt lgkmcnt(0)
    s_barrier
    ds_read_b128 v[16:19], v3 offset:1536
    ds_read_b128 v[20:23], v3 offset:9728
    ds_read_b128 v[24:27], v4 offset:768
    ds_read_b128 v[28:31], v4 offset:784
    v_add_u32 v3, 2048, v3
    v_add_u32 v4, 1024, v4
    s_waitcnt vmcnt(8)
    v_cvt_f32_i32 v48, v160
    v_cvt_f32_i32 v49, v164
    v_cvt_f32_i32 v50, v168
    v_cvt_f32_i32 v51, v172
    s_movrels_b32 s12, s72
    s_add_u32 s14, s14, 1
    s_add_u32 s28, s8, s12
    s_addc_u32 s29, s9, 0
    s_mov_b32 m0, s14
    buffer_load_dwordx4 v[224:227], v2, s[28:31], 0 offen
    v_cvt_f32_i32 v52, v176
    v_cvt_f32_i32 v53, v180
    v_cvt_f32_i32 v54, v184
    v_cvt_f32_i32 v55, v188
    v_fma_f32 v48, v48, v32, v36
    v_fma_f32 v49, v49, v32, v36
    v_fma_f32 v50, v50, v32, v36
    v_fma_f32 v51, v51, v32, v36
    v_fma_f32 v52, v52, v32, v36
    v_fma_f32 v53, v53, v32, v36
    v_fma_f32 v54, v54, v32, v36
    v_fma_f32 v55, v55, v32, v36
    v_mul_f32 v48, v48, v40
    v_mul_f32 v49, v49, v41
    v_mul_f32 v50, v50, v42
    v_mul_f32 v51, v51, v43
    v_mul_f32 v52, v52, v44
    v_mul_f32 v53, v53, v45
    v_mul_f32 v54, v54, v46
    v_mul_f32 v55, v55, v47
    buffer_load_dwordx4 v[228:231], v2, s[28:31], s44 offen
    v_cvt_pk_bf16_f32 v64, v48, v49
    v_cvt_pk_bf16_f32 v65, v50, v51
    v_cvt_pk_bf16_f32 v66, v52, v53
    v_cvt_pk_bf16_f32 v67, v54, v55
    ds_write_b128 v5, v[64:67] offset:16384
    v_cvt_f32_i32 v56, v161
    v_cvt_f32_i32 v57, v165
    v_cvt_f32_i32 v58, v169
    v_cvt_f32_i32 v59, v173
    v_cvt_f32_i32 v60, v177
    v_cvt_f32_i32 v61, v181
    v_cvt_f32_i32 v62, v185
    v_cvt_f32_i32 v63, v189
    v_fma_f32 v56, v56, v33, v37
    v_fma_f32 v57, v57, v33, v37
    v_fma_f32 v58, v58, v33, v37
    v_fma_f32 v59, v59, v33, v37
    v_fma_f32 v60, v60, v33, v37
    v_fma_f32 v61, v61, v33, v37
    v_fma_f32 v62, v62, v33, v37
    v_fma_f32 v63, v63, v33, v37
    buffer_load_dwordx4 v[232:235], v2, s[28:31], s45 offen
    v_mul_f32 v56, v56, v40
    v_mul_f32 v57, v57, v41
    v_mul_f32 v58, v58, v42
    v_mul_f32 v59, v59, v43
    v_mul_f32 v60, v60, v44
    v_mul_f32 v61, v61, v45
    v_mul_f32 v62, v62, v46
    v_mul_f32 v63, v63, v47
    v_cvt_pk_bf16_f32 v68, v56, v57
    v_cvt_pk_bf16_f32 v69, v58, v59
    v_cvt_pk_bf16_f32 v70, v60, v61
    v_cvt_pk_bf16_f32 v71, v62, v63
    ds_write_b128 v5, v[68:71] offset:16512
    buffer_load_dwordx4 v[236:239], v2, s[28:31], s46 offen
    v_cvt_f32_i32 v48, v162
    v_cvt_f32_i32 v49, v166
    v_cvt_f32_i32 v50, v170
    v_cvt_f32_i32 v51, v174
    v_cvt_f32_i32 v52, v178
    v_cvt_f32_i32 v53, v182
    v_cvt_f32_i32 v54, v186
    v_cvt_f32_i32 v55, v190
    v_fma_f32 v48, v48, v34, v38
    v_fma_f32 v49, v49, v34, v38
    v_fma_f32 v50, v50, v34, v38
    v_fma_f32 v51, v51, v34, v38
    v_fma_f32 v52, v52, v34, v38
    v_fma_f32 v53, v53, v34, v38
    v_fma_f32 v54, v54, v34, v38
    v_fma_f32 v55, v55, v34, v38
    v_mul_f32 v48, v48, v40
    v_mul_f32 v49, v49, v41
    v_mul_f32 v50, v50, v42
    v_mul_f32 v51, v51, v43
    v_mul_f32 v52, v52, v44
    v_mul_f32 v53, v53, v45
    v_mul_f32 v54, v54, v46
    v_mul_f32 v55, v55, v47
    buffer_load_dwordx4 v[240:243], v2, s[28:31], s47 offen
    v_cvt_pk_bf16_f32 v72, v48, v49
    v_cvt_pk_bf16_f32 v73, v50, v51
    v_cvt_pk_bf16_f32 v74, v52, v53
    v_cvt_pk_bf16_f32 v75, v54, v55
    ds_write_b128 v6, v[72:75] offset:16640
    v_cvt_f32_i32 v56, v163
    v_cvt_f32_i32 v57, v167
    v_cvt_f32_i32 v58, v171
    v_cvt_f32_i32 v59, v175
    buffer_load_dwordx4 v[244:247], v2, s[28:31], s48 offen
    v_cvt_f32_i32 v60, v179
    v_cvt_f32_i32 v61, v183
    v_cvt_f32_i32 v62, v187
    v_cvt_f32_i32 v63, v191
    v_fma_f32 v56, v56, v35, v39
    v_fma_f32 v57, v57, v35, v39
    v_fma_f32 v58, v58, v35, v39
    v_fma_f32 v59, v59, v35, v39
    v_fma_f32 v60, v60, v35, v39
    v_fma_f32 v61, v61, v35, v39
    v_fma_f32 v62, v62, v35, v39
    v_fma_f32 v63, v63, v35, v39
    v_mul_f32 v56, v56, v40
    v_mul_f32 v57, v57, v41
    v_mul_f32 v58, v58, v42
    v_mul_f32 v59, v59, v43
    v_mul_f32 v60, v60, v44
    v_mul_f32 v61, v61, v45
    v_mul_f32 v62, v62, v46
    v_mul_f32 v63, v63, v47
    v_cvt_pk_bf16_f32 v76, v56, v57
    v_cvt_pk_bf16_f32 v77, v58, v59
    v_cvt_pk_bf16_f32 v78, v60, v61
    v_cvt_pk_bf16_f32 v79, v62, v63
    ds_write_b128 v6, v[76:79] offset:16768
    buffer_load_dwordx4 v[248:251], v2, s[28:31], s49 offen
    buffer_load_dwordx4 v[252:255], v2, s[28:31], s50 offen
    s_waitcnt lgkmcnt(0)
    s_barrier
    s_cmp_lt_u32 s14, 16
    s_cbranch_scc1 L_ploop
    ds_read_b128 v[32:35], v3 offset:0
    ds_read_b128 v[36:39], v3 offset:8192
    ds_read_b128 v[40:43], v4 offset:0
    ds_read_b128 v[44:47], v4 offset:16
    s_waitcnt vmcnt(8)
    v_cvt_f32_i32 v48, v192
    v_cvt_f32_i32 v49, v196
    v_cvt_f32_i32 v50, v200
    v_cvt_f32_i32 v51, v204
    v_cvt_f32_i32 v52, v208
    v_cvt_f32_i32 v53, v212
    v_cvt_f32_i32 v54, v216
    v_cvt_f32_i32 v55, v220
    s_nop 0
    v_fma_f32 v48, v48, v16, v20
    v_fma_f32 v49, v49, v16, v20
    v_fma_f32 v50, v50, v16, v20
    v_fma_f32 v51, v51, v16, v20
    v_fma_f32 v52, v52, v16, v20
    v_fma_f32 v53, v53, v16, v20
    v_fma_f32 v54, v54, v16, v20
    v_fma_f32 v55, v55, v16, v20
    v_mul_f32 v48, v48, v24
    v_mul_f32 v49, v49, v25
    v_mul_f32 v50, v50, v26
    v_mul_f32 v51, v51, v27
    v_mul_f32 v52, v52, v28
    v_mul_f32 v53, v53, v29
    v_mul_f32 v54, v54, v30
    v_mul_f32 v55, v55, v31
    v_cvt_pk_bf16_f32 v64, v48, v49
    v_cvt_pk_bf16_f32 v65, v50, v51
    v_cvt_pk_bf16_f32 v66, v52, v53
    v_cvt_pk_bf16_f32 v67, v54, v55
    ds_write_b128 v5, v[64:67] offset:0
    v_cvt_f32_i32 v56, v193
    v_cvt_f32_i32 v57, v197
    v_cvt_f32_i32 v58, v201
    v_cvt_f32_i32 v59, v205
    v_cvt_f32_i32 v60, v209
    v_cvt_f32_i32 v61, v213
    v_cvt_f32_i32 v62, v217
    v_cvt_f32_i32 v63, v221
    v_fma_f32 v56, v56, v17, v21
    v_fma_f32 v57, v57, v17, v21
    v_fma_f32 v58, v58, v17, v21
    v_fma_f32 v59, v59, v17, v21
    v_fma_f32 v60, v60, v17, v21
    v_fma_f32 v61, v61, v17, v21
    v_fma_f32 v62, v62, v17, v21
    v_fma_f32 v63, v63, v17, v21
    v_mul_f32 v56, v56, v24
    v_mul_f32 v57, v57, v25
    v_mul_f32 v58, v58, v26
    v_mul_f32 v59, v59, v27
    v_mul_f32 v60, v60, v28
    v_mul_f32 v61, v61, v29
    v_mul_f32 v62, v62, v30
    v_mul_f32 v63, v63, v31
    v_cvt_pk_bf16_f32 v68, v56, v57
    v_cvt_pk_bf16_f32 v69, v58, v59
    v_cvt_pk_bf16_f32 v70, v60, v61
    v_cvt_pk_bf16_f32 v71, v62, v63
    ds_write_b128 v5, v[68:71] offset:128
    v_cvt_f32_i32 v48, v194
    v_cvt_f32_i32 v49, v198
    v_cvt_f32_i32 v50, v202
    v_cvt_f32_i32 v51, v206
    v_cvt_f32_i32 v52, v210
    v_cvt_f32_i32 v53, v214
    v_cvt_f32_i32 v54, v218
    v_cvt_f32_i32 v55, v222
    v_fma_f32 v48, v48, v18, v22
    v_fma_f32 v49, v49, v18, v22
    v_fma_f32 v50, v50, v18, v22
    v_fma_f32 v51, v51, v18, v22
    v_fma_f32 v52, v52, v18, v22
    v_fma_f32 v53, v53, v18, v22
    v_fma_f32 v54, v54, v18, v22
    v_fma_f32 v55, v55, v18, v22
    v_mul_f32 v48, v48, v24
    v_mul_f32 v49, v49, v25
    v_mul_f32 v50, v50, v26
    v_mul_f32 v51, v51, v27
    v_mul_f32 v52, v52, v28
    v_mul_f32 v53, v53, v29
    v_mul_f32 v54, v54, v30
    v_mul_f32 v55, v55, v31
    v_cvt_pk_bf16_f32 v72, v48, v49
    v_cvt_pk_bf16_f32 v73, v50, v51
    v_cvt_pk_bf16_f32 v74, v52, v53
    v_cvt_pk_bf16_f32 v75, v54, v55
    ds_write_b128 v6, v[72:75] offset:256
    v_cvt_f32_i32 v56, v195
    v_cvt_f32_i32 v57, v199
    v_cvt_f32_i32 v58, v203
    v_cvt_f32_i32 v59, v207
    v_cvt_f32_i32 v60, v211
    v_cvt_f32_i32 v61, v215
    v_cvt_f32_i32 v62, v219
    v_cvt_f32_i32 v63, v223
    v_fma_f32 v56, v56, v19, v23
    v_fma_f32 v57, v57, v19, v23
    v_fma_f32 v58, v58, v19, v23
    v_fma_f32 v59, v59, v19, v23
    v_fma_f32 v60, v60, v19, v23
    v_fma_f32 v61, v61, v19, v23
    v_fma_f32 v62, v62, v19, v23
    v_fma_f32 v63, v63, v19, v23
    v_mul_f32 v56, v56, v24
    v_mul_f32 v57, v57, v25
    v_mul_f32 v58, v58, v26
    v_mul_f32 v59, v59, v27
    v_mul_f32 v60, v60, v28
    v_mul_f32 v61, v61, v29
    v_mul_f32 v62, v62, v30
    v_mul_f32 v63, v63, v31
    v_cvt_pk_bf16_f32 v76, v56, v57
    v_cvt_pk_bf16_f32 v77, v58, v59
    v_cvt_pk_bf16_f32 v78, v60, v61
    v_cvt_pk_bf16_f32 v79, v62, v63
    ds_write_b128 v6, v[76:79] offset:384
    s_waitcnt lgkmcnt(0)
    s_barrier
    s_waitcnt vmcnt(0)
    v_cvt_f32_i32 v48, v224
    v_cvt_f32_i32 v49, v228
    v_cvt_f32_i32 v50, v232
    v_cvt_f32_i32 v51, v236
    v_cvt_f32_i32 v52, v240
    v_cvt_f32_i32 v53, v244
    v_cvt_f32_i32 v54, v248
    v_cvt_f32_i32 v55, v252
    s_nop 0
    v_fma_f32 v48, v48, v32, v36
    v_fma_f32 v49, v49, v32, v36
    v_fma_f32 v50, v50, v32, v36
    v_fma_f32 v51, v51, v32, v36
    v_fma_f32 v52, v52, v32, v36
    v_fma_f32 v53, v53, v32, v36
    v_fma_f32 v54, v54, v32, v36
    v_fma_f32 v55, v55, v32, v36
    v_mul_f32 v48, v48, v40
    v_mul_f32 v49, v49, v41
    v_mul_f32 v50, v50, v42
    v_mul_f32 v51, v51, v43
    v_mul_f32 v52, v52, v44
    v_mul_f32 v53, v53, v45
    v_mul_f32 v54, v54, v46
    v_mul_f32 v55, v55, v47
    v_cvt_pk_bf16_f32 v64, v48, v49
    v_cvt_pk_bf16_f32 v65, v50, v51
    v_cvt_pk_bf16_f32 v66, v52, v53
    v_cvt_pk_bf16_f32 v67, v54, v55
    ds_write_b128 v5, v[64:67] offset:16384
    v_cvt_f32_i32 v56, v225
    v_cvt_f32_i32 v57, v229
    v_cvt_f32_i32 v58, v233
    v_cvt_f32_i32 v59, v237
    v_cvt_f32_i32 v60, v241
    v_cvt_f32_i32 v61, v245
    v_cvt_f32_i32 v62, v249
    v_cvt_f32_i32 v63, v253
    v_fma_f32 v56, v56, v33, v37
    v_fma_f32 v57, v57, v33, v37
    v_fma_f32 v58, v58, v33, v37
    v_fma_f32 v59, v59, v33, v37
    v_fma_f32 v60, v60, v33, v37
    v_fma_f32 v61, v61, v33, v37
    v_fma_f32 v62, v62, v33, v37
    v_fma_f32 v63, v63, v33, v37
    v_mul_f32 v56, v56, v40
    v_mul_f32 v57, v57, v41
    v_mul_f32 v58, v58, v42
    v_mul_f32 v59, v59, v43
    v_mul_f32 v60, v60, v44
    v_mul_f32 v61, v61, v45
    v_mul_f32 v62, v62, v46
    v_mul_f32 v63, v63, v47
    v_cvt_pk_bf16_f32 v68, v56, v57
    v_cvt_pk_bf16_f32 v69, v58, v59
    v_cvt_pk_bf16_f32 v70, v60, v61
    v_cvt_pk_bf16_f32 v71, v62, v63
    ds_write_b128 v5, v[68:71] offset:16512
    v_cvt_f32_i32 v48, v226
    v_cvt_f32_i32 v49, v230
    v_cvt_f32_i32 v50, v234
    v_cvt_f32_i32 v51, v238
    v_cvt_f32_i32 v52, v242
    v_cvt_f32_i32 v53, v246
    v_cvt_f32_i32 v54, v250
    v_cvt_f32_i32 v55, v254
    v_fma_f32 v48, v48, v34, v38
    v_fma_f32 v49, v49, v34, v38
    v_fma_f32 v50, v50, v34, v38
    v_fma_f32 v51, v51, v34, v38
    v_fma_f32 v52, v52, v34, v38
    v_fma_f32 v53, v53, v34, v38
    v_fma_f32 v54, v54, v34, v38
    v_fma_f32 v55, v55, v34, v38
    v_mul_f32 v48, v48, v40
    v_mul_f32 v49, v49, v41
    v_mul_f32 v50, v50, v42
    v_mul_f32 v51, v51, v43
    v_mul_f32 v52, v52, v44
    v_mul_f32 v53, v53, v45
    v_mul_f32 v54, v54, v46
    v_mul_f32 v55, v55, v47
    v_cvt_pk_bf16_f32 v72, v48, v49
    v_cvt_pk_bf16_f32 v73, v50, v51
    v_cvt_pk_bf16_f32 v74, v52, v53
    v_cvt_pk_bf16_f32 v75, v54, v55
    ds_write_b128 v6, v[72:75] offset:16640
    v_cvt_f32_i32 v56, v227
    v_cvt_f32_i32 v57, v231
    v_cvt_f32_i32 v58, v235
    v_cvt_f32_i32 v59, v239
    v_cvt_f32_i32 v60, v243
    v_cvt_f32_i32 v61, v247
    v_cvt_f32_i32 v62, v251
    v_cvt_f32_i32 v63, v255
    v_fma_f32 v56, v56, v35, v39
    v_fma_f32 v57, v57, v35, v39
    v_fma_f32 v58, v58, v35, v39
    v_fma_f32 v59, v59, v35, v39
    v_fma_f32 v60, v60, v35, v39
    v_fma_f32 v61, v61, v35, v39
    v_fma_f32 v62, v62, v35, v39
    v_fma_f32 v63, v63, v35, v39
    v_mul_f32 v56, v56, v40
    v_mul_f32 v57, v57, v41
    v_mul_f32 v58, v58, v42
    v_mul_f32 v59, v59, v43
    v_mul_f32 v60, v60, v44
    v_mul_f32 v61, v61, v45
    v_mul_f32 v62, v62, v46
    v_mul_f32 v63, v63, v47
    v_cvt_pk_bf16_f32 v76, v56, v57
    v_cvt_pk_bf16_f32 v77, v58, v59
    v_cvt_pk_bf16_f32 v78, v60, v61
    v_cvt_pk_bf16_f32 v79, v62, v63
    ds_write_b128 v6, v[76:79] offset:16768
    s_waitcnt lgkmcnt(0)
    s_barrier
L_end:
    s_endpgm
L_prefetch:
    s_load_dwordx2 s[4:5], s[0:1], 0
    v_lshrrev_b32 v1, 6, v0
    v_and_b32 v7, 63, v0
    s_and_b32 s16, s2, 7
    v_readfirstlane_b32 s18, v1
    s_sub_u32 s17, s2, 224
    s_lshr_b32 s17, s17, 3
    s_and_b32 s19, s16, 1
    s_lshl_b32 s19, s19, 2
    s_add_u32 s19, s19, s17
    s_mul_i32 s93, s17, 2
    s_and_b32 s21, s16, 1
    s_mul_i32 s21, s21, 1
    s_add_u32 s93, s93, s21
    s_and_b32 s93, s93, 7
    s_and_b32 s20, s18, 3
    s_lshr_b32 s21, s18, 2
    s_lshl_b32 s20, s20, 6
    v_add_u32 v2, s20, v7
    v_lshlrev_b32 v2, 11, v2
    s_lshl_b32 s22, s19, 19
    s_mov_b32 s26, 522368
    s_mov_b32 s27, 0x20000
    s_add_u32 s6, s21, 0
    s_waitcnt lgkmcnt(0)
    s_add_u32 s4, s4, s22
    s_addc_u32 s5, s5, 0
    s_and_b32 s5, s5, 0xffff
L_pfx:
    s_add_u32 s12, s93, s6
    s_and_b32 s12, s12, 7
    s_and_b32 s13, s6, 8
    s_or_b32 s12, s12, s13
    s_lshl_b32 s12, s12, 7
    s_add_u32 s24, s4, s12
    s_addc_u32 s25, s5, 0
    buffer_load_dword v8, v2, s[24:27], 0 offen
    s_add_u32 s6, s6, 2
    s_cmp_lt_u32 s6, 16
    s_cbranch_scc1 L_pfx
    s_endpgm
.section .rodata,"a"
.p2align 6
.amdhsa_kernel standalone__weight_only_int_omniquant__prompt_kernel
  .amdhsa_next_free_vgpr 256
  .amdhsa_next_free_sgpr 96
  .amdhsa_accum_offset 256
  .amdhsa_group_segment_fixed_size 0
  .amdhsa_kernarg_size 64
  .amdhsa_user_sgpr_count 2
  .amdhsa_user_sgpr_kernarg_segment_ptr 1
  .amdhsa_system_sgpr_workgroup_id_x 1
.end_amdhsa_kernel
```
